```python
import torch

def _softmax(x, axis=-1):
    return torch.softmax(x, dim=axis)
def _gelu(x):
    return torch.nn.functional.gelu(x, approximate="tanh")
def _silu(x):
    return torch.nn.functional.silu(x)
def _sigmoid(x):
    return torch.sigmoid(x)
def _layernorm(x, axis=-1, eps=1e-5):
    m = x.mean(dim=axis, keepdim=True)
    v = x.var(dim=axis, keepdim=True, unbiased=False)
    return (x - m) / torch.sqrt(v + eps)
def _scatter_add(tgt, idx, src, axis=0):
    return tgt.clone().index_add_(axis, idx, src)
def _segment_sum(src, seg, n):
    out = torch.zeros((n,) + src.shape[1:], dtype=src.dtype)
    return out.index_add_(0, seg, src)
def _pad(x, pw):
    flat = tuple(v for pair in reversed(pw) for v in pair)
    return torch.nn.functional.pad(x, flat)

kernel_name = 'concat_heads__ssm_conv_s4d__ssm_conv_s5__prompt'

def setup_inputs():

    _w = (lambda a: (lambda t: t.to(torch.bfloat16) if t.is_floating_point() else t)(torch.as_tensor(a)))
    def _A_setup():
        Bsz, L, D, N = 1, 2048, 448, 256
        return {
            "u": _w((lambda *s: torch.randn(*s, dtype=torch.bfloat16) * 0.05)(Bsz, L, D)),
            "log_A_real": _w((lambda *s: torch.randn(*s, dtype=torch.bfloat16) * 3.2)(D, N) * 0.5),
            "A_imag": _w((lambda *s: torch.randn(*s, dtype=torch.bfloat16) * 0.05)(D, N) * 3.14),
            "C_real": _w((lambda *s: torch.randn(*s, dtype=torch.bfloat16) * 0.1)(D, N) / N ** 0.5),
            "C_imag": _w((lambda *s: torch.randn(*s, dtype=torch.bfloat16) * 0.1)(D, N) / N ** 0.5),
            "log_dt": _w((lambda *s: torch.randn(*s, dtype=torch.bfloat16) * 0.05)(D) * 0.5 - 4.0),
            "D_skip": _w((lambda *s: torch.randn(*s, dtype=torch.bfloat16) * 0.05)(D)),
        }
    _A_in = _A_setup()

    def _B_setup():
        B, S, D = 1, 2048, 448
        P = D
        Lambda_re = -0.5 * (lambda _x: torch.exp(torch.as_tensor(_x)))((lambda *s: torch.randn(*s, dtype=torch.bfloat16) * 0.2)(P))
        Lambda_im = (lambda *s: torch.randn(*s, dtype=torch.bfloat16) * 0.4)(P) * 1.0
        B_re = (lambda *s: torch.randn(*s, dtype=torch.bfloat16) * 0.2)(P, D) * (D ** -0.5)
        B_im = (lambda *s: torch.randn(*s, dtype=torch.bfloat16) * 0.2)(P, D) * (D ** -0.5)
        C_re = (lambda *s: torch.randn(*s, dtype=torch.bfloat16) * 0.2)(D, P) * (P ** -0.5)
        C_im = (lambda *s: torch.randn(*s, dtype=torch.bfloat16) * 0.2)(D, P) * (P ** -0.5)
        log_dt = (lambda *s: torch.randn(*s, dtype=torch.bfloat16) * 0.2)(P) * 0.3 - 2.0
        Dskip = (lambda *s: torch.randn(*s, dtype=torch.bfloat16) * 0.05)(D)
        return {
            "x": _w((lambda *s: torch.randn(*s, dtype=torch.bfloat16) * 0.05)(B, S, D)),
            "Lambda_re": _w(Lambda_re),
            "Lambda_im": _w(Lambda_im),
            "B_re": _w(B_re),
            "B_im": _w(B_im),
            "C_re": _w(C_re),
            "C_im": _w(C_im),
            "log_dt": _w(log_dt),
            "Dskip": _w(Dskip),
        }
    _B_in = _B_setup()

    return {
        "A_u": _A_in["u"],
        "A_log_A_real": _A_in["log_A_real"],
        "A_A_imag": _A_in["A_imag"],
        "A_C_real": _A_in["C_real"],
        "A_C_imag": _A_in["C_imag"],
        "A_log_dt": _A_in["log_dt"],
        "A_D_skip": _A_in["D_skip"],
        "B_x": _B_in["x"],
        "B_Lambda_re": _B_in["Lambda_re"],
        "B_Lambda_im": _B_in["Lambda_im"],
        "B_B_re": _B_in["B_re"],
        "B_B_im": _B_in["B_im"],
        "B_C_re": _B_in["C_re"],
        "B_C_im": _B_in["C_im"],
        "B_log_dt": _B_in["log_dt"],
        "B_Dskip": _B_in["Dskip"],
    }

def reference(A_u, A_log_A_real, A_A_imag, A_C_real, A_C_imag, A_log_dt, A_D_skip, B_x, B_Lambda_re, B_Lambda_im, B_B_re, B_B_im, B_C_re, B_C_im, B_log_dt, B_Dskip):
    def _A_ref(u, log_A_real, A_imag, C_real, C_imag, log_dt, D_skip):
        L = u.shape[1]
        dt = torch.exp(log_dt)
        A = -torch.exp(log_A_real) + 1j * A_imag
        C = (C_real + 1j * C_imag) * dt[:, None]
        pos = (lambda x, dt: x.to(dt))(torch.arange(L), log_dt.dtype)
        P = torch.exp((A * dt[:, None])[:, :, None] * pos[None, None, :])
        K = 2.0 * torch.einsum("dn,dnl->dl", C, P).real
        L2 = 2 * L
        u_t = (lambda x, *d: x.permute(*d))(u, 0, 2, 1)
        Kf = (lambda x, *a, **k: torch.fft.rfft(x.float(), *a, **k))(K, L2)
        Uf = (lambda x, *a, **k: torch.fft.rfft(x.float(), *a, **k))(u_t, L2)
        y = (lambda x, *a, **k: torch.fft.irfft(x, *a, **k).to(torch.bfloat16))(Uf * Kf[None, :, :], L2)[:, :, :L]
        y = (lambda x, *d: x.permute(*d))(y, 0, 2, 1)
        return y + u * D_skip[None, None, :]

    def _B_ref(x, Lambda_re, Lambda_im, B_re, B_im, C_re, C_im, log_dt, Dskip):
        Bsz, L, H = x.shape
        Lam = Lambda_re + 1j * Lambda_im
        Bmat = B_re + 1j * B_im
        Cmat = C_re + 1j * C_im
        dt = torch.exp(log_dt)
        Lam_bar = torch.exp(dt * Lam)
        B_bar = ((Lam_bar - 1.0) / Lam)[:, None] * Bmat
        Bu = torch.einsum("bld,pd->blp", x + 0j, B_bar)
        h = torch.zeros_like(Bu[:, 0, :])
        hs = []
        for t in range(L):
            h = Lam_bar[None, :] * h + Bu[:, t, :]
            hs.append(h)
        hseq = torch.stack(hs, 1)
        y = 2.0 * torch.einsum("blp,dp->bld", hseq, Cmat).real + x * Dskip[None, None, :]
        return y

    a = _A_ref(A_u, A_log_A_real, A_A_imag, A_C_real, A_C_imag, A_log_dt, A_D_skip)
    b = _B_ref(B_x, B_Lambda_re, B_Lambda_im, B_B_re, B_B_im, B_C_re, B_C_im, B_log_dt, B_Dskip)
    return torch.concatenate([a, b], axis=-1)
```

```asm
; @launch grid=(448,1,1) block=(256,1,1) lds=81920
.amdgcn_target "amdgcn-amd-amdhsa--gfx950"
.text
.globl concat_heads__ssm_conv_s4d__ssm_conv_s5__prompt_kernel
.p2align 8
.type concat_heads__ssm_conv_s4d__ssm_conv_s5__prompt_kernel,@function
concat_heads__ssm_conv_s4d__ssm_conv_s5__prompt_kernel:
    s_cmp_ge_u32 s2, 448
    s_cbranch_scc1 L_end
    s_load_dwordx4 s[80:83], s[0:1], 128
    s_load_dwordx2 s[84:85], s[0:1], 144
    s_cmp_ge_u32 s2, 224
    s_cbranch_scc1 L_roleB
    s_load_dwordx16 s[64:79], s[0:1], 0
    s_setprio 3
    v_lshrrev_b32 v3, 6, v0
    v_and_b32 v1, 63, v0
    v_mov_b32 v2, 0
    v_readfirstlane_b32 s3, v3
    s_and_b32 s30, s2, 7
    s_lshr_b32 s31, s2, 3
    s_mul_i32 s36, s30, 28
    s_add_u32 s36, s36, s31
    s_lshr_b32 s37, s36, 5
    s_and_b32 s38, s36, 31
    s_lshr_b32 s39, s2, 5
    s_and_b32 s40, s2, 31
    v_lshrrev_b32 v3, 3, v1
    v_mul_u32_u24 v3, 896, v3
    v_and_b32_e64 v4, 7, v1
    v_lshl_add_u32 v3, v4, 4, v3
    s_and_b32 s41, s3, 1
    s_lshr_b32 s42, s3, 1
    s_lshl_b32 s30, s40, 2
    s_add_u32 s30, s30, s3
    s_mul_i32 s44, s30, 14336
    s_lshl_b32 s30, s39, 7
    s_add_u32 s44, s44, s30
    s_mul_i32 s45, s3, 2112
    s_add_u32 s45, s45, 56320
    s_lshl_b32 s30, s36, 2
    s_add_u32 s30, s30, s3
    s_lshl_b32 s30, s30, 8
    v_lshl_add_u32 v4, v1, 2, s30
    s_lshl_b32 s30, s39, 7
    v_lshl_add_u32 v5, v1, 1, s30
    s_lshl_b32 s46, s36, 2
    s_getpc_b64 s[54:55]
L_pc:
    s_sub_u32 s54, s54, L_pc-concat_heads__ssm_conv_s4d__ssm_conv_s5__prompt_kernel
    s_subb_u32 s55, s55, 0
    s_lshr_b32 s30, s2, 3
    s_lshl_b32 s30, s30, 2
    s_add_u32 s30, s30, s3
    s_lshl_b32 s30, s30, 8
    v_lshl_add_u32 v6, v1, 7, s30
    s_mov_b32 s31, L_codeend-concat_heads__ssm_conv_s4d__ssm_conv_s5__prompt_kernel
    v_cmp_gt_u32_e64 vcc, s31, v6
    s_mov_b32 m0, s45
    s_and_b32 exec_lo, vcc_lo, 3
    s_mov_b32 exec_hi, 0
    global_load_dword v90, v6, s[54:55]
    s_mov_b64 exec, -1
    s_waitcnt lgkmcnt(0)
    s_mov_b32 s20, s64
    s_mov_b32 s21, s65
    s_mov_b32 s22, 0x1c0000
    s_mov_b32 s23, 0x20000
    buffer_load_dwordx4 v3, s[20:23], s44 offen lds
    s_add_u32 m0, s45, 1056
    s_add_u32 s44, s44, 7168
    buffer_load_dwordx4 v3, s[20:23], s44 offen lds
    global_load_dword v20, v4, s[66:67]
    global_load_dword v21, v4, s[68:69]
    global_load_dword v22, v4, s[70:71]
    global_load_dword v23, v4, s[72:73]
    global_load_ushort v18, v5, s[76:77]
    s_load_dword s43, s[74:75], s46
    s_mov_b32 s12, s80
    s_mov_b32 s13, s81
    s_mov_b32 s14, 0x700000
    s_mov_b32 s15, 0x20000
    s_mov_b32 s16, s82
    s_mov_b32 s17, s83
    s_mov_b32 s18, 0x100
    s_mov_b32 s19, 0x20000
    s_mov_b32 s8, s84
    s_mov_b32 s9, s85
    s_mov_b32 s10, 0x1000000
    s_mov_b32 s11, 0x20000
    s_mov_b32 s29, 0
    s_mov_b32 s34, 0xffff0000
    s_or_b32 s30, s2, s3
    s_cmp_lg_u32 s30, 0
    s_cbranch_scc1 L_a_nononce
    s_memrealtime s[30:31]
    s_waitcnt lgkmcnt(0)
    s_or_b32 s30, s30, 1
    v_mov_b32 v6, s30
    v_mov_b32_e64 v7, 0
    s_mov_b64 exec, 1
    buffer_atomic_cmpswap v[6:7], v2, s[16:19], 0 offen sc1
    s_mov_b64 exec, -1
L_a_nononce:
    s_mul_i32 s31, s42, 27136
    s_mul_i32 s30, s41, 4224
    s_add_u32 s30, s30, s31
    v_lshl_add_u32 v8, v1, 2, s30
    s_mov_b32 exec_hi, 0
    s_mov_b32 exec_lo, 0xfffffff
    ds_write_b32 v8, v2
    s_mov_b64 exec, -1
    s_mul_i32 s30, s41, 9272
    s_add_u32 s30, s30, s31
    s_nop 0
    s_add_u32 s30, s30, 8460
    v_lshl_add_u32 v8, v1, 2, s30
    ds_write_b32 v8, v2 offset:0
    ds_write_b32 v8, v2 offset:256
    ds_write_b32 v8, v2 offset:4636
    ds_write_b32 v8, v2 offset:4892
    v_and_b32 v8, 31, v1
    v_lshrrev_b32 v9, 5, v1
    v_lshlrev_b32 v9, 4, v9
    v_sub_u32 v8, v8, v9
    v_mov_b32 v9, 0x3f80
    v_mov_b32 v7, 0x3f800000
    v_cmp_eq_u32 vcc, 0, v8
    v_cmp_eq_u32 s[52:53], 1, v8
    s_nop 0
    v_cndmask_b32 v78, 0, v9, vcc
    v_cndmask_b32 v78, v78, v7, s[52:53]
    v_cmp_eq_u32_e64 vcc, 2, v8
    v_cmp_eq_u32 s[52:53], 3, v8
    s_nop 0
    v_cndmask_b32 v79, 0, v9, vcc
    v_cndmask_b32 v79, v79, v7, s[52:53]
    v_cmp_eq_u32_e64 vcc, 4, v8
    v_cmp_eq_u32 s[52:53], 5, v8
    s_nop 0
    v_cndmask_b32 v80, 0, v9, vcc
    v_cndmask_b32 v80, v80, v7, s[52:53]
    v_cmp_eq_u32_e64 vcc, 6, v8
    v_cmp_eq_u32 s[52:53], 7, v8
    s_nop 0
    v_cndmask_b32 v81, 0, v9, vcc
    v_cndmask_b32 v81, v81, v7, s[52:53]
    v_cmp_eq_u32_e64 vcc, 8, v8
    v_cmp_eq_u32 s[52:53], 9, v8
    s_nop 0
    v_cndmask_b32 v82, 0, v9, vcc
    v_cndmask_b32 v82, v82, v7, s[52:53]
    v_cmp_eq_u32_e64 vcc, 10, v8
    v_cmp_eq_u32 s[52:53], 11, v8
    s_nop 0
    v_cndmask_b32 v83, 0, v9, vcc
    v_cndmask_b32 v83, v83, v7, s[52:53]
    v_cmp_eq_u32_e64 vcc, 12, v8
    v_cmp_eq_u32 s[52:53], 13, v8
    s_nop 0
    v_cndmask_b32 v84, 0, v9, vcc
    v_cndmask_b32 v84, v84, v7, s[52:53]
    v_cmp_eq_u32_e64 vcc, 14, v8
    v_cmp_eq_u32 s[52:53], 15, v8
    s_nop 0
    v_cndmask_b32 v85, 0, v9, vcc
    v_cndmask_b32 v85, v85, v7, s[52:53]
    s_mov_b32 s53, 0x07060302
    v_bfe_u32 v6, v1, 1, 2
    v_mul_u32_u24 v6, 1056, v6
    v_lshrrev_b32_e64 v7, 3, v1
    v_lshl_add_u32 v6, v7, 2, v6
    v_and_b32_e64 v8, 1, v1
    v_lshl_add_u32 v6, v8, 1, v6
    s_mul_i32 s30, s42, 4224
    s_lshl_b32 s31, s41, 6
    s_add_u32 s30, s30, s31
    s_add_u32 s30, s30, 56320
    v_add_u32 v6, s30, v6
    v_lshlrev_b32 v7, 13, v7
    v_and_b32_e64 v8, 7, v1
    v_lshl_add_u32 v7, v8, 4, v7
    s_lshl_b32 s30, s39, 5
    s_lshl_b32 s31, s41, 4
    s_add_u32 s30, s30, s31
    s_lshl_b32 s47, s30, 13
    s_lshl_b32 s30, s40, 1
    s_add_u32 s30, s30, s42
    s_lshl_b32 s30, s30, 7
    s_add_u32 s47, s47, s30
    s_add_u32 s46, s47, 65536
    s_waitcnt vmcnt(5)
    s_waitcnt lgkmcnt(0)
    s_barrier
    s_nop 0
    ds_read_u16 v40, v6 offset:0
    ds_read_u16 v41, v6 offset:128
    ds_read_u16 v42, v6 offset:256
    ds_read_u16 v43, v6 offset:384
    ds_read_u16 v44, v6 offset:512
    ds_read_u16 v45, v6 offset:640
    ds_read_u16 v46, v6 offset:768
    ds_read_u16 v47, v6 offset:896
    ds_read_u16 v48, v6 offset:32
    ds_read_u16 v49, v6 offset:160
    ds_read_u16 v50, v6 offset:288
    ds_read_u16 v51, v6 offset:416
    ds_read_u16 v52, v6 offset:544
    ds_read_u16 v53, v6 offset:672
    ds_read_u16 v54, v6 offset:800
    ds_read_u16 v55, v6 offset:928
    s_waitcnt lgkmcnt(8)
    s_nop 0
    v_lshl_or_b32 v10, v41, 16, v40
    v_lshl_or_b32 v11, v43, 16, v42
    v_lshl_or_b32 v12, v45, 16, v44
    v_lshl_or_b32 v13, v47, 16, v46
    buffer_store_dwordx4 v[10:13], v7, s[8:11], s47 offen sc1
    s_waitcnt lgkmcnt(0)
    s_nop 0
    v_lshl_or_b32 v14, v49, 16, v48
    v_lshl_or_b32 v15, v51, 16, v50
    v_lshl_or_b32 v16, v53, 16, v52
    v_lshl_or_b32 v17, v55, 16, v54
    buffer_store_dwordx4 v[14:17], v7, s[8:11], s46 offen sc1
    buffer_load_dword v19, v2, s[16:19], 0 offen sc1
    s_setprio 0
    s_lshl_b32 s30, s43, 16
    s_and_b32 s31, s43, s34
    s_cmp_eq_u32 s42, 0
    s_cselect_b32 s30, s30, s31
    v_mov_b32 v9, 0x3fb8aa3b
    v_mul_f32 v9, s30, v9
    v_exp_f32 v9, v9
    s_nop 0
    v_cvt_pk_bf16_f32 v9, v9, v9
    v_lshlrev_b32 v9, 16, v9
    s_waitcnt vmcnt(3)
    v_lshlrev_b32 v24, 16, v20
    v_and_b32 v25, s34, v20
    v_mul_f32 v24, 0x3fb8aa3b, v24
    v_mul_f32 v25, 0x3fb8aa3b, v25
    v_exp_f32 v24, v24
    v_exp_f32 v25, v25
    v_lshlrev_b32 v26, 16, v21
    v_and_b32 v27, s34, v21
    v_cvt_pk_bf16_f32 v20, v24, v25
    v_mul_f32 v26, v26, v9
    v_mul_f32 v27, v27, v9
    v_lshlrev_b32 v24, 16, v20
    v_and_b32 v25, s34, v20
    v_mul_f32 v26, 0x3e22f983, v26
    v_mul_f32 v27, 0x3e22f983, v27
    v_mul_f32 v24, v24, v9
    v_mul_f32 v25, v25, v9
    v_mul_f32 v24, 0xbfb8aa3b, v24
    v_mul_f32 v25, 0xbfb8aa3b, v25
    v_mul_f32 v5, 0x41000000, v24
    v_mul_f32 v6, 0x41000000, v26
    v_exp_f32 v5, v5
    v_fract_f32 v6, v6
    v_cos_f32 v32, v6
    v_sin_f32 v34, v6
    s_nop 0
    v_mul_f32 v32, v32, v5
    v_mul_f32_e64 v34, v34, v5
    v_mul_f32 v5, 0x41000000, v25
    v_mul_f32 v6, 0x41000000, v27
    v_exp_f32 v5, v5
    v_fract_f32 v6, v6
    v_cos_f32 v33, v6
    v_sin_f32 v35, v6
    s_nop 0
    v_mul_f32 v33, v33, v5
    v_mul_f32 v35, v35, v5
    s_mov_b32 s58, 0
    v_sub_f32 v56, 0, v34
    v_sub_f32 v57, 0, v35
    v_cvt_pk_bf16_f32 v96, 1.0, v32
    v_cvt_pk_bf16_f32 v100, 0, v34
    v_cvt_pk_bf16_f32 v104, 1.0, v33
    v_cvt_pk_bf16_f32 v108, 0, v35
    v_mul_f32 v48, v32, v32
    v_mul_f32 v49, v33, v33
    v_mul_f32 v50, v34, v32
    v_mul_f32 v51, v35, v33
    v_fmac_f32 v48, v34, v56
    v_fmac_f32 v49, v35, v57
    v_fmac_f32 v50, v32, v34
    v_fmac_f32 v51, v33, v35
    v_mul_f32 v52, v48, v32
    v_mul_f32 v53, v49, v33
    v_mul_f32 v54, v50, v32
    v_mul_f32 v55, v51, v33
    v_fmac_f32 v52, v50, v56
    v_fmac_f32 v53, v51, v57
    v_fmac_f32 v54, v48, v34
    v_fmac_f32 v55, v49, v35
    v_cvt_pk_bf16_f32 v97, v48, v52
    v_cvt_pk_bf16_f32 v101, v50, v54
    v_cvt_pk_bf16_f32 v105, v49, v53
    v_cvt_pk_bf16_f32 v109, v51, v55
    v_mul_f32 v48, v52, v32
    v_mul_f32 v49, v53, v33
    v_mul_f32 v50, v54, v32
    v_mul_f32 v51, v55, v33
    v_fmac_f32 v48, v54, v56
    v_fmac_f32 v49, v55, v57
    v_fmac_f32 v50, v52, v34
    v_fmac_f32 v51, v53, v35
    v_mul_f32 v52, v48, v32
    v_mul_f32 v53, v49, v33
    v_mul_f32 v54, v50, v32
    v_mul_f32 v55, v51, v33
    v_fmac_f32 v52, v50, v56
    v_fmac_f32 v53, v51, v57
    v_fmac_f32 v54, v48, v34
    v_fmac_f32 v55, v49, v35
    v_cvt_pk_bf16_f32 v98, v48, v52
    v_cvt_pk_bf16_f32 v102, v50, v54
    v_cvt_pk_bf16_f32 v106, v49, v53
    v_cvt_pk_bf16_f32 v110, v51, v55
    v_mul_f32 v48, v52, v32
    v_mul_f32 v49, v53, v33
    v_mul_f32 v50, v54, v32
    v_mul_f32 v51, v55, v33
    v_fmac_f32 v48, v54, v56
    v_fmac_f32 v49, v55, v57
    v_fmac_f32 v50, v52, v34
    v_fmac_f32 v51, v53, v35
    v_mul_f32 v52, v48, v32
    v_mul_f32 v53, v49, v33
    v_mul_f32 v54, v50, v32
    v_mul_f32 v55, v51, v33
    v_fmac_f32 v52, v50, v56
    v_fmac_f32 v53, v51, v57
    v_fmac_f32 v54, v48, v34
    v_fmac_f32 v55, v49, v35
    v_cvt_pk_bf16_f32 v99, v48, v52
    v_cvt_pk_bf16_f32 v103, v50, v54
    v_cvt_pk_bf16_f32 v107, v49, v53
    v_cvt_pk_bf16_f32 v111, v51, v55
    v_mul_f32 v48, v52, v32
    v_mul_f32 v49, v53, v33
    v_mul_f32 v50, v54, v32
    v_mul_f32 v51, v55, v33
    v_fmac_f32 v48, v54, v56
    v_fmac_f32 v49, v55, v57
    v_fmac_f32 v50, v52, v34
    v_fmac_f32 v51, v53, v35
    v_mfma_f32_32x32x16_bf16 v[128:143], v[96:99], v[78:81], 0
    v_mul_f32 v52, v48, v32
    v_mul_f32 v53, v49, v33
    v_mul_f32 v54, v50, v32
    v_mul_f32 v55, v51, v33
    v_fmac_f32 v52, v50, v56
    v_fmac_f32 v53, v51, v57
    v_fmac_f32 v54, v48, v34
    v_fmac_f32 v55, v49, v35
    v_mfma_f32_32x32x16_bf16 v[144:159], v[100:103], v[78:81], 0
    v_cvt_pk_bf16_f32 v10, v48, v52
    v_cvt_pk_bf16_f32 v14, v50, v54
    v_cvt_pk_bf16_f32 v88, v49, v53
    v_cvt_pk_bf16_f32 v92, v51, v55
    v_mul_f32 v48, v52, v32
    v_mul_f32 v49, v53, v33
    v_mul_f32 v50, v54, v32
    v_mul_f32 v51, v55, v33
    v_fmac_f32 v48, v54, v56
    v_fmac_f32 v49, v55, v57
    v_fmac_f32 v50, v52, v34
    v_fmac_f32 v51, v53, v35
    v_mfma_f32_32x32x16_bf16 v[160:175], v[104:107], v[78:81], 0
    v_mul_f32 v52, v48, v32
    v_mul_f32 v53, v49, v33
    v_mul_f32 v54, v50, v32
    v_mul_f32 v55, v51, v33
    v_fmac_f32 v52, v50, v56
    v_fmac_f32 v53, v51, v57
    v_fmac_f32 v54, v48, v34
    v_fmac_f32 v55, v49, v35
    v_mfma_f32_32x32x16_bf16 v[176:191], v[108:111], v[78:81], 0
    v_cvt_pk_bf16_f32 v11, v48, v52
    v_cvt_pk_bf16_f32 v15, v50, v54
    v_cvt_pk_bf16_f32 v89, v49, v53
    v_cvt_pk_bf16_f32 v93, v51, v55
    v_mul_f32 v48, v52, v32
    v_mul_f32 v49, v53, v33
    v_mul_f32 v50, v54, v32
    v_mul_f32 v51, v55, v33
    v_fmac_f32 v48, v54, v56
    v_fmac_f32 v49, v55, v57
    v_fmac_f32 v50, v52, v34
    v_fmac_f32 v51, v53, v35
    v_mul_f32 v52, v48, v32
    v_mul_f32 v53, v49, v33
    v_mul_f32 v54, v50, v32
    v_mul_f32 v55, v51, v33
    v_fmac_f32 v52, v50, v56
    v_fmac_f32 v53, v51, v57
    v_fmac_f32 v54, v48, v34
    v_fmac_f32 v55, v49, v35
    v_cvt_pk_bf16_f32 v12, v48, v52
    v_cvt_pk_bf16_f32 v16, v50, v54
    v_cvt_pk_bf16_f32 v90, v49, v53
    v_cvt_pk_bf16_f32 v94, v51, v55
    v_mul_f32 v48, v52, v32
    v_mul_f32 v49, v53, v33
    v_mul_f32 v50, v54, v32
    v_mul_f32 v51, v55, v33
    v_fmac_f32 v48, v54, v56
    v_fmac_f32 v49, v55, v57
    v_fmac_f32 v50, v52, v34
    v_fmac_f32 v51, v53, v35
    v_mul_f32 v52, v48, v32
    v_mul_f32 v53, v49, v33
    v_mul_f32 v54, v50, v32
    v_mul_f32 v55, v51, v33
    v_fmac_f32 v52, v50, v56
    v_fmac_f32 v53, v51, v57
    v_fmac_f32 v54, v48, v34
    v_fmac_f32 v55, v49, v35
    v_cvt_pk_bf16_f32 v13, v48, v52
    v_cvt_pk_bf16_f32 v17, v50, v54
    v_cvt_pk_bf16_f32 v91, v49, v53
    v_cvt_pk_bf16_f32 v95, v51, v55
    s_getreg_b32 s30, hwreg(HW_REG_IB_STS, 0, 4)
    s_mov_b32 s59, 0
    s_or_b32 s30, s30, s58
    s_cbranch_scc0 L_a_post
L_a_pb0:
    v_mul_f32 v48, v52, v32
    v_mul_f32 v49, v53, v33
    v_mul_f32 v50, v54, v32
    v_mul_f32 v51, v55, v33
    v_fmac_f32 v48, v54, v56
    v_fmac_f32 v49, v55, v57
    v_fmac_f32 v50, v52, v34
    v_fmac_f32 v51, v53, v35
    v_mfma_f32_32x32x16_bf16 v[128:143], v[10:13], v[82:85], v[128:143]
    v_mul_f32 v52, v48, v32
    v_mul_f32 v53, v49, v33
    v_mul_f32 v54, v50, v32
    v_mul_f32 v55, v51, v33
    v_fmac_f32 v52, v50, v56
    v_fmac_f32 v53, v51, v57
    v_fmac_f32 v54, v48, v34
    v_fmac_f32 v55, v49, v35
    v_mfma_f32_32x32x16_bf16 v[144:159], v[14:17], v[82:85], v[144:159]
    v_cvt_pk_bf16_f32 v96, v48, v52
    v_cvt_pk_bf16_f32 v100, v50, v54
    v_cvt_pk_bf16_f32 v104, v49, v53
    v_cvt_pk_bf16_f32 v108, v51, v55
    v_mul_f32 v48, v52, v32
    v_mul_f32 v49, v53, v33
    v_mul_f32 v50, v54, v32
    v_mul_f32 v51, v55, v33
    v_fmac_f32 v48, v54, v56
    v_fmac_f32 v49, v55, v57
    v_fmac_f32 v50, v52, v34
    v_fmac_f32 v51, v53, v35
    v_mfma_f32_32x32x16_bf16 v[160:175], v[88:91], v[82:85], v[160:175]
    v_mul_f32 v52, v48, v32
    v_mul_f32 v53, v49, v33
    v_mul_f32 v54, v50, v32
    v_mul_f32 v55, v51, v33
    v_fmac_f32 v52, v50, v56
    v_fmac_f32 v53, v51, v57
    v_fmac_f32 v54, v48, v34
    v_fmac_f32 v55, v49, v35
    v_mfma_f32_32x32x16_bf16 v[176:191], v[92:95], v[82:85], v[176:191]
    v_cvt_pk_bf16_f32 v97, v48, v52
    v_cvt_pk_bf16_f32 v101, v50, v54
    v_cvt_pk_bf16_f32 v105, v49, v53
    v_cvt_pk_bf16_f32 v109, v51, v55
    s_getreg_b32 s30, hwreg(HW_REG_IB_STS, 0, 4)
    s_mov_b32 s59, 1
    s_or_b32 s30, s30, s58
    s_cbranch_scc0 L_a_post
L_a_pb1:
    v_mul_f32 v48, v52, v32
    v_mul_f32 v49, v53, v33
    v_mul_f32 v50, v54, v32
    v_mul_f32 v51, v55, v33
    v_fmac_f32 v48, v54, v56
    v_fmac_f32 v49, v55, v57
    v_fmac_f32 v50, v52, v34
    v_fmac_f32 v51, v53, v35
    v_mul_f32 v52, v48, v32
    v_mul_f32 v53, v49, v33
    v_mul_f32 v54, v50, v32
    v_mul_f32 v55, v51, v33
    v_fmac_f32 v52, v50, v56
    v_fmac_f32 v53, v51, v57
    v_fmac_f32 v54, v48, v34
    v_fmac_f32 v55, v49, v35
    v_cvt_pk_bf16_f32 v98, v48, v52
    v_cvt_pk_bf16_f32 v102, v50, v54
    v_cvt_pk_bf16_f32 v106, v49, v53
    v_cvt_pk_bf16_f32 v110, v51, v55
    v_mul_f32 v48, v52, v32
    v_mul_f32 v49, v53, v33
    v_mul_f32 v50, v54, v32
    v_mul_f32 v51, v55, v33
    v_fmac_f32 v48, v54, v56
    v_fmac_f32 v49, v55, v57
    v_fmac_f32 v50, v52, v34
    v_fmac_f32 v51, v53, v35
    v_mul_f32 v52, v48, v32
    v_mul_f32 v53, v49, v33
    v_mul_f32 v54, v50, v32
    v_mul_f32 v55, v51, v33
    v_fmac_f32 v52, v50, v56
    v_fmac_f32 v53, v51, v57
    v_fmac_f32 v54, v48, v34
    v_fmac_f32 v55, v49, v35
    v_cvt_pk_bf16_f32 v99, v48, v52
    v_cvt_pk_bf16_f32 v103, v50, v54
    v_cvt_pk_bf16_f32 v107, v49, v53
    v_cvt_pk_bf16_f32 v111, v51, v55
    v_perm_b32 v192, v129, v128, s53
    v_perm_b32 v193, v131, v130, s53
    v_perm_b32 v194, v133, v132, s53
    v_perm_b32 v195, v135, v134, s53
    v_perm_b32 v196, v137, v136, s53
    v_perm_b32 v197, v139, v138, s53
    v_perm_b32 v198, v141, v140, s53
    v_perm_b32 v199, v143, v142, s53
    v_perm_b32 v200, v145, v144, s53
    v_perm_b32 v201, v147, v146, s53
    v_perm_b32 v202, v149, v148, s53
    v_perm_b32 v203, v151, v150, s53
    v_perm_b32 v204, v153, v152, s53
    v_perm_b32 v205, v155, v154, s53
    v_perm_b32 v206, v157, v156, s53
    v_perm_b32 v207, v159, v158, s53
    v_perm_b32 v208, v161, v160, s53
    v_perm_b32 v209, v163, v162, s53
    v_perm_b32 v210, v165, v164, s53
    v_perm_b32 v211, v167, v166, s53
    v_perm_b32 v212, v169, v168, s53
    v_perm_b32 v213, v171, v170, s53
    v_perm_b32 v214, v173, v172, s53
    v_perm_b32 v215, v175, v174, s53
    v_perm_b32 v216, v177, v176, s53
    v_perm_b32 v217, v179, v178, s53
    v_perm_b32 v218, v181, v180, s53
    v_perm_b32 v219, v183, v182, s53
    v_perm_b32 v220, v185, v184, s53
    v_perm_b32 v221, v187, v186, s53
    v_perm_b32 v222, v189, v188, s53
    v_perm_b32 v223, v191, v190, s53
    s_getreg_b32 s30, hwreg(HW_REG_IB_STS, 0, 4)
    s_mov_b32 s59, 2
    s_or_b32 s30, s30, s58
    s_cbranch_scc0 L_a_post
L_a_pb2:
    v_mul_f32 v48, v52, v32
    v_mul_f32 v49, v53, v33
    v_mul_f32 v50, v54, v32
    v_mul_f32 v51, v55, v33
    v_fmac_f32 v48, v54, v56
    v_fmac_f32 v49, v55, v57
    v_fmac_f32 v50, v52, v34
    v_fmac_f32 v51, v53, v35
    v_mfma_f32_32x32x16_bf16 v[128:143], v[96:99], v[78:81], 0
    v_mul_f32 v52, v48, v32
    v_mul_f32 v53, v49, v33
    v_mul_f32 v54, v50, v32
    v_mul_f32 v55, v51, v33
    v_fmac_f32 v52, v50, v56
    v_fmac_f32 v53, v51, v57
    v_fmac_f32 v54, v48, v34
    v_fmac_f32 v55, v49, v35
    v_mfma_f32_32x32x16_bf16 v[144:159], v[100:103], v[78:81], 0
    v_cvt_pk_bf16_f32 v10, v48, v52
    v_cvt_pk_bf16_f32 v14, v50, v54
    v_cvt_pk_bf16_f32 v88, v49, v53
    v_cvt_pk_bf16_f32 v92, v51, v55
    v_mul_f32 v48, v52, v32
    v_mul_f32 v49, v53, v33
    v_mul_f32 v50, v54, v32
    v_mul_f32 v51, v55, v33
    v_fmac_f32 v48, v54, v56
    v_fmac_f32 v49, v55, v57
    v_fmac_f32 v50, v52, v34
    v_fmac_f32 v51, v53, v35
    v_mfma_f32_32x32x16_bf16 v[160:175], v[104:107], v[78:81], 0
    v_mul_f32 v52, v48, v32
    v_mul_f32 v53, v49, v33
    v_mul_f32 v54, v50, v32
    v_mul_f32 v55, v51, v33
    v_fmac_f32 v52, v50, v56
    v_fmac_f32 v53, v51, v57
    v_fmac_f32 v54, v48, v34
    v_fmac_f32 v55, v49, v35
    v_mfma_f32_32x32x16_bf16 v[176:191], v[108:111], v[78:81], 0
    v_cvt_pk_bf16_f32 v11, v48, v52
    v_cvt_pk_bf16_f32 v15, v50, v54
    v_cvt_pk_bf16_f32 v89, v49, v53
    v_cvt_pk_bf16_f32 v93, v51, v55
    s_getreg_b32 s30, hwreg(HW_REG_IB_STS, 0, 4)
    s_mov_b32 s59, 3
    s_or_b32 s30, s30, s58
    s_cbranch_scc0 L_a_post
L_a_pb3:
    v_mul_f32 v48, v52, v32
    v_mul_f32 v49, v53, v33
    v_mul_f32 v50, v54, v32
    v_mul_f32 v51, v55, v33
    v_fmac_f32 v48, v54, v56
    v_fmac_f32 v49, v55, v57
    v_fmac_f32 v50, v52, v34
    v_fmac_f32 v51, v53, v35
    v_mul_f32 v52, v48, v32
    v_mul_f32 v53, v49, v33
    v_mul_f32 v54, v50, v32
    v_mul_f32 v55, v51, v33
    v_fmac_f32 v52, v50, v56
    v_fmac_f32 v53, v51, v57
    v_fmac_f32 v54, v48, v34
    v_fmac_f32 v55, v49, v35
    v_cvt_pk_bf16_f32 v12, v48, v52
    v_cvt_pk_bf16_f32 v16, v50, v54
    v_cvt_pk_bf16_f32 v90, v49, v53
    v_cvt_pk_bf16_f32 v94, v51, v55
    v_mul_f32 v48, v52, v32
    v_mul_f32 v49, v53, v33
    v_mul_f32 v50, v54, v32
    v_mul_f32 v51, v55, v33
    v_fmac_f32 v48, v54, v56
    v_fmac_f32 v49, v55, v57
    v_fmac_f32 v50, v52, v34
    v_fmac_f32 v51, v53, v35
    v_mul_f32 v52, v48, v32
    v_mul_f32 v53, v49, v33
    v_mul_f32 v54, v50, v32
    v_mul_f32 v55, v51, v33
    v_fmac_f32 v52, v50, v56
    v_fmac_f32 v53, v51, v57
    v_fmac_f32 v54, v48, v34
    v_fmac_f32 v55, v49, v35
    v_cvt_pk_bf16_f32 v13, v48, v52
    v_cvt_pk_bf16_f32 v17, v50, v54
    v_cvt_pk_bf16_f32 v91, v49, v53
    v_cvt_pk_bf16_f32 v95, v51, v55
    s_getreg_b32 s30, hwreg(HW_REG_IB_STS, 0, 4)
    s_mov_b32 s59, 4
    s_or_b32 s30, s30, s58
    s_cbranch_scc0 L_a_post
L_a_pb4:
    v_mov_b32 v5, v24
    v_mov_b32 v7, v26
    v_exp_f32 v5, v5
    v_fract_f32 v7, v7
    v_cos_f32 v28, v7
    v_sin_f32 v30, v7
    s_nop 0
    v_mul_f32 v28, v28, v5
    v_mul_f32_e64 v30, v30, v5
    v_mul_f32 v5, 0x43800000, v24
    v_mul_f32 v7, 0x43800000, v26
    v_exp_f32 v5, v5
    v_fract_f32 v7, v7
    v_cos_f32 v36, v7
    v_sin_f32 v38, v7
    s_nop 0
    v_mul_f32 v36, v36, v5
    v_mul_f32 v38, v38, v5
    v_mov_b32 v5, v25
    v_mov_b32 v7, v27
    v_exp_f32 v5, v5
    v_fract_f32 v7, v7
    v_cos_f32 v29, v7
    v_sin_f32 v31, v7
    s_nop 0
    v_mul_f32 v29, v29, v5
    v_mul_f32 v31, v31, v5
    v_mul_f32 v5, 0x43800000, v25
    v_mul_f32 v7, 0x43800000, v27
    v_exp_f32 v5, v5
    v_fract_f32 v7, v7
    v_cos_f32 v37, v7
    v_sin_f32 v39, v7
    s_nop 0
    v_mul_f32 v37, v37, v5
    v_mul_f32 v39, v39, v5
    v_add_f32 v5, v9, v9
    v_lshlrev_b32 v32, 16, v22
    v_and_b32 v33, s34, v22
    v_lshlrev_b32 v34, 16, v23
    v_and_b32 v35, s34, v23
    v_mul_f32 v32, v32, v5
    v_mul_f32 v33, v33, v5
    v_mul_f32_e64 v34, v34, -v5
    v_mul_f32_e64 v35, v35, -v5
    v_sub_f32 v56, 0, v38
    v_sub_f32 v57, 0, v39
    v_sub_f32 v20, 0, v30
    v_sub_f32 v21, 0, v31
    v_mfma_f32_32x32x16_bf16 v[128:143], v[10:13], v[82:85], v[128:143]
    v_mfma_f32_32x32x16_bf16 v[144:159], v[14:17], v[82:85], v[144:159]
    v_mul_f32 v66, v32, v36
    v_mul_f32 v67, v33, v37
    v_mul_f32 v68, v34, v36
    v_mul_f32 v69, v35, v37
    v_fmac_f32 v66, v34, v38
    v_fmac_f32 v67, v35, v39
    v_fmac_f32 v68, v32, v56
    v_fmac_f32 v69, v33, v57
    v_mfma_f32_32x32x16_bf16 v[160:175], v[88:91], v[82:85], v[160:175]
    v_cvt_pk_bf16_f32 v96, v32, v66
    v_cvt_pk_bf16_f32 v100, v34, v68
    v_cvt_pk_bf16_f32 v104, v33, v67
    v_cvt_pk_bf16_f32 v108, v35, v69
    v_mul_f32 v70, v66, v36
    v_mul_f32 v71, v67, v37
    v_mul_f32 v72, v68, v36
    v_mul_f32 v73, v69, v37
    v_fmac_f32 v70, v68, v38
    v_fmac_f32 v71, v69, v39
    v_fmac_f32 v72, v66, v56
    v_fmac_f32 v73, v67, v57
    v_mfma_f32_32x32x16_bf16 v[176:191], v[92:95], v[82:85], v[176:191]
    v_mul_f32 v74, v70, v36
    v_mul_f32 v75, v71, v37
    v_mul_f32 v76, v72, v36
    v_mul_f32 v77, v73, v37
    v_fmac_f32 v74, v72, v38
    v_fmac_f32 v75, v73, v39
    v_fmac_f32 v76, v70, v56
    v_fmac_f32 v77, v71, v57
    v_cvt_pk_bf16_f32 v97, v70, v74
    v_cvt_pk_bf16_f32 v101, v72, v76
    v_cvt_pk_bf16_f32 v105, v71, v75
    v_cvt_pk_bf16_f32 v109, v73, v77
    s_getreg_b32 s30, hwreg(HW_REG_IB_STS, 0, 4)
    s_mov_b32 s59, 5
    s_or_b32 s30, s30, s58
    s_cbranch_scc0 L_a_post
L_a_pb5:
    v_mul_f32 v58, v74, v36
    v_mul_f32 v59, v75, v37
    v_mul_f32 v60, v76, v36
    v_mul_f32 v61, v77, v37
    v_fmac_f32 v58, v76, v38
    v_fmac_f32 v59, v77, v39
    v_fmac_f32 v60, v74, v56
    v_fmac_f32 v61, v75, v57
    v_mul_f32 v62, v58, v36
    v_mul_f32 v63, v59, v37
    v_mul_f32 v64, v60, v36
    v_mul_f32 v65, v61, v37
    v_fmac_f32 v62, v60, v38
    v_fmac_f32 v63, v61, v39
    v_fmac_f32 v64, v58, v56
    v_fmac_f32 v65, v59, v57
    v_cvt_pk_bf16_f32 v98, v58, v62
    v_cvt_pk_bf16_f32 v102, v60, v64
    v_cvt_pk_bf16_f32 v106, v59, v63
    v_cvt_pk_bf16_f32 v110, v61, v65
    v_mul_f32 v58, v62, v36
    v_mul_f32 v59, v63, v37
    v_mul_f32 v60, v64, v36
    v_mul_f32 v61, v65, v37
    v_fmac_f32 v58, v64, v38
    v_fmac_f32 v59, v65, v39
    v_fmac_f32 v60, v62, v56
    v_fmac_f32 v61, v63, v57
    v_mul_f32 v62, v58, v36
    v_mul_f32 v63, v59, v37
    v_mul_f32 v64, v60, v36
    v_mul_f32 v65, v61, v37
    v_fmac_f32 v62, v60, v38
    v_fmac_f32 v63, v61, v39
    v_fmac_f32 v64, v58, v56
    v_fmac_f32 v65, v59, v57
    v_cvt_pk_bf16_f32 v99, v58, v62
    v_cvt_pk_bf16_f32 v103, v60, v64
    v_cvt_pk_bf16_f32 v107, v59, v63
    v_cvt_pk_bf16_f32 v111, v61, v65
    v_perm_b32 v224, v129, v128, s53
    v_perm_b32 v225, v131, v130, s53
    v_perm_b32 v226, v133, v132, s53
    v_perm_b32 v227, v135, v134, s53
    v_perm_b32 v228, v137, v136, s53
    v_perm_b32 v229, v139, v138, s53
    v_perm_b32 v230, v141, v140, s53
    v_perm_b32 v231, v143, v142, s53
    v_perm_b32 v232, v145, v144, s53
    v_perm_b32 v233, v147, v146, s53
    v_perm_b32 v234, v149, v148, s53
    v_perm_b32 v235, v151, v150, s53
    v_perm_b32 v236, v153, v152, s53
    v_perm_b32 v237, v155, v154, s53
    v_perm_b32 v238, v157, v156, s53
    v_perm_b32 v239, v159, v158, s53
    v_perm_b32 v240, v161, v160, s53
    v_perm_b32 v241, v163, v162, s53
    v_perm_b32 v242, v165, v164, s53
    v_perm_b32 v243, v167, v166, s53
    v_perm_b32 v244, v169, v168, s53
    v_perm_b32 v245, v171, v170, s53
    v_perm_b32 v246, v173, v172, s53
    v_perm_b32 v247, v175, v174, s53
    v_perm_b32 v248, v177, v176, s53
    v_perm_b32 v249, v179, v178, s53
    v_perm_b32 v250, v181, v180, s53
    v_perm_b32 v251, v183, v182, s53
    v_perm_b32 v252, v185, v184, s53
    v_perm_b32 v253, v187, v186, s53
    v_perm_b32 v254, v189, v188, s53
    v_perm_b32 v255, v191, v190, s53
    s_getreg_b32 s30, hwreg(HW_REG_IB_STS, 0, 4)
    s_mov_b32 s59, 6
    s_or_b32 s30, s30, s58
    s_cbranch_scc0 L_a_post
L_a_pb6:
    v_mul_f32 v58, v62, v36
    v_mul_f32 v59, v63, v37
    v_mul_f32 v60, v64, v36
    v_mul_f32 v61, v65, v37
    v_fmac_f32 v58, v64, v38
    v_fmac_f32 v59, v65, v39
    v_fmac_f32 v60, v62, v56
    v_fmac_f32 v61, v63, v57
    v_mfma_f32_32x32x16_bf16 v[128:143], v[96:99], v[78:81], 0
    v_mul_f32 v48, v32, v28
    v_mul_f32 v49, v33, v29
    v_mul_f32 v50, v34, v28
    v_mul_f32 v51, v35, v29
    v_fmac_f32 v48, v34, v30
    v_fmac_f32 v49, v35, v31
    v_fmac_f32 v50, v32, v20
    v_fmac_f32 v51, v33, v21
    v_mfma_f32_32x32x16_bf16 v[144:159], v[100:103], v[78:81], 0
    v_cvt_pk_bf16_f32 v10, v58, v48
    v_cvt_pk_bf16_f32 v14, v60, v50
    v_cvt_pk_bf16_f32 v88, v59, v49
    v_cvt_pk_bf16_f32 v92, v61, v51
    v_mul_f32 v52, v48, v28
    v_mul_f32 v53, v49, v29
    v_mul_f32 v54, v50, v28
    v_mul_f32 v55, v51, v29
    v_fmac_f32 v52, v50, v30
    v_fmac_f32 v53, v51, v31
    v_fmac_f32 v54, v48, v20
    v_fmac_f32 v55, v49, v21
    v_mfma_f32_32x32x16_bf16 v[160:175], v[104:107], v[78:81], 0
    v_mul_f32 v48, v52, v28
    v_mul_f32 v49, v53, v29
    v_mul_f32 v50, v54, v28
    v_mul_f32 v51, v55, v29
    v_fmac_f32 v48, v54, v30
    v_fmac_f32 v49, v55, v31
    v_fmac_f32 v50, v52, v20
    v_fmac_f32 v51, v53, v21
    v_mfma_f32_32x32x16_bf16 v[176:191], v[108:111], v[78:81], 0
    v_cvt_pk_bf16_f32 v11, v52, v48
    v_cvt_pk_bf16_f32 v15, v54, v50
    v_cvt_pk_bf16_f32 v89, v53, v49
    v_cvt_pk_bf16_f32 v93, v55, v51
    s_getreg_b32 s30, hwreg(HW_REG_IB_STS, 0, 4)
    s_mov_b32 s59, 7
    s_or_b32 s30, s30, s58
    s_cbranch_scc0 L_a_post
L_a_pb7:
    v_mul_f32 v52, v48, v28
    v_mul_f32 v53, v49, v29
    v_mul_f32 v54, v50, v28
    v_mul_f32 v55, v51, v29
    v_fmac_f32 v52, v50, v30
    v_fmac_f32 v53, v51, v31
    v_fmac_f32 v54, v48, v20
    v_fmac_f32 v55, v49, v21
    v_mul_f32 v48, v52, v28
    v_mul_f32 v49, v53, v29
    v_mul_f32 v50, v54, v28
    v_mul_f32 v51, v55, v29
    v_fmac_f32 v48, v54, v30
    v_fmac_f32 v49, v55, v31
    v_fmac_f32 v50, v52, v20
    v_fmac_f32 v51, v53, v21
    v_cvt_pk_bf16_f32 v12, v52, v48
    v_cvt_pk_bf16_f32 v16, v54, v50
    v_cvt_pk_bf16_f32 v90, v53, v49
    v_cvt_pk_bf16_f32 v94, v55, v51
    v_mul_f32 v52, v48, v28
    v_mul_f32 v53, v49, v29
    v_mul_f32 v54, v50, v28
    v_mul_f32 v55, v51, v29
    v_fmac_f32 v52, v50, v30
    v_fmac_f32 v53, v51, v31
    v_fmac_f32 v54, v48, v20
    v_fmac_f32 v55, v49, v21
    v_mul_f32 v48, v52, v28
    v_mul_f32 v49, v53, v29
    v_mul_f32 v50, v54, v28
    v_mul_f32 v51, v55, v29
    v_fmac_f32 v48, v54, v30
    v_fmac_f32 v49, v55, v31
    v_fmac_f32 v50, v52, v20
    v_fmac_f32 v51, v53, v21
    v_cvt_pk_bf16_f32 v13, v52, v48
    v_cvt_pk_bf16_f32 v17, v54, v50
    v_cvt_pk_bf16_f32 v91, v53, v49
    v_cvt_pk_bf16_f32 v95, v55, v51
    v_mul_f32 v40, v28, v28
    v_mul_f32 v41, v29, v29
    v_mul_f32 v42, v30, v28
    v_mul_f32 v43, v31, v29
    v_fmac_f32 v40, v30, v20
    v_fmac_f32 v41, v31, v21
    v_fmac_f32 v42, v28, v30
    v_fmac_f32 v43, v29, v31
    v_sub_f32 v56, 0, v42
    v_sub_f32 v57, 0, v43
    v_mfma_f32_32x32x16_bf16 v[128:143], v[10:13], v[82:85], v[128:143]
    v_mul_f32 v44, v40, v40
    v_mul_f32 v45, v41, v41
    v_mul_f32 v46, v42, v40
    v_mul_f32 v47, v43, v41
    v_fmac_f32 v44, v42, v56
    v_fmac_f32 v45, v43, v57
    v_fmac_f32 v46, v40, v42
    v_fmac_f32 v47, v41, v43
    v_sub_f32 v20, 0, v46
    v_sub_f32 v21, 0, v47
    v_mfma_f32_32x32x16_bf16 v[144:159], v[14:17], v[82:85], v[144:159]
    v_mul_f32 v48, v66, v40
    v_mul_f32 v49, v67, v41
    v_mul_f32 v50, v68, v40
    v_mul_f32 v51, v69, v41
    v_fmac_f32 v48, v68, v42
    v_fmac_f32 v49, v69, v43
    v_fmac_f32 v50, v66, v56
    v_fmac_f32 v51, v67, v57
    v_mfma_f32_32x32x16_bf16 v[160:175], v[88:91], v[82:85], v[160:175]
    v_mul_f32 v52, v48, v40
    v_mul_f32 v53, v49, v41
    v_mul_f32 v54, v50, v40
    v_mul_f32 v55, v51, v41
    v_fmac_f32 v52, v50, v42
    v_fmac_f32 v53, v51, v43
    v_fmac_f32 v54, v48, v56
    v_fmac_f32 v55, v49, v57
    v_mfma_f32_32x32x16_bf16 v[176:191], v[92:95], v[82:85], v[176:191]
    v_cvt_pk_bf16_f32 v96, v48, v52
    v_cvt_pk_bf16_f32 v100, v50, v54
    v_cvt_pk_bf16_f32 v104, v49, v53
    v_cvt_pk_bf16_f32 v108, v51, v55
    s_cmp_lg_u32 s58, 0
    s_cbranch_scc1 L_a_posted
    s_waitcnt vmcnt(0)
    s_getreg_b32 s30, hwreg(HW_REG_IB_STS, 0, 4)
    s_mov_b32 s59, 8
    s_or_b32 s30, s30, s58
    s_cbranch_scc0 L_a_post
L_a_pb8:
L_a_posted:
    v_and_b32 v3, 31, v1
    s_lshl_b32 s30, s39, 5
    v_add_u32 v4, s30, v3
    v_mul_u32_u24 v6, 2341, v4
    v_lshrrev_b32 v6, 16, v6
    v_mul_u32_u24 v22, 28, v6
    v_sub_u32_e64 v4, v4, v22
    v_lshl_add_u32 v4, v4, 3, v6
    s_lshl_b32 s30, s37, 5
    v_add_u32 v3, s30, v3
    s_mov_b32 s49, 0x900000
    v_lshlrev_b32 v6, 7, v3
    v_lshlrev_b32 v19, 7, v4
    v_lshrrev_b32 v3, 1, v0
    v_and_b32 v4, 1, v0
    v_lshlrev_b32 v24, 4, v0
    s_lshl_b32 s50, s36, 13
    s_add_u32 s51, s50, 4096
    v_mul_u32_u24 v25, 27136, v4
    v_lshl_add_u32 v25, v3, 4, v25
    s_setprio 3
    s_cmp_lg_u32 s3, 0
    s_cbranch_scc1 L_a1_skip
    s_mov_b32 exec_hi, 0
L_a1_poll:
    buffer_load_dwordx4 v[88:91], v6, s[8:11], s49 offen sc1
    s_add_u32 s29, s29, 1
    s_cmp_gt_u32 s29, 131072
    s_cbranch_scc1 L_end
    s_waitcnt vmcnt(0)
    v_xor_b32 v88, s28, v88
    v_xor_b32 v89, s28, v89
    v_xor_b32 v90, s28, v90
    v_xor_b32_e64 v91, s28, v91
    v_or3_b32 v88, v88, v89, v90
    v_or_b32 v88, v88, v91
    v_cmp_ne_u32_e64 vcc, 0, v88
    s_cbranch_vccnz L_a1_poll
    s_mov_b64 exec, -1
L_a1_skip:
    s_barrier
    buffer_load_dwordx4 v[88:91], v24, s[8:11], s50 offen sc1
    buffer_load_dwordx4 v[92:95], v24, s[8:11], s51 offen sc1
    s_setprio 0
    v_mul_f32 v48, v52, v40
    v_mul_f32 v49, v53, v41
    v_mul_f32 v50, v54, v40
    v_mul_f32 v51, v55, v41
    v_fmac_f32 v48, v54, v42
    v_fmac_f32 v49, v55, v43
    v_fmac_f32 v50, v52, v56
    v_fmac_f32 v51, v53, v57
    v_mul_f32 v52, v70, v44
    v_mul_f32 v53, v71, v45
    v_mul_f32 v54, v72, v44
    v_mul_f32 v55, v73, v45
    v_fmac_f32 v52, v72, v46
    v_fmac_f32 v53, v73, v47
    v_fmac_f32 v54, v70, v20
    v_fmac_f32_e64 v55, v71, v21
    v_cvt_pk_bf16_f32 v97, v48, v52
    v_cvt_pk_bf16_f32 v101, v50, v54
    v_cvt_pk_bf16_f32 v105, v49, v53
    v_cvt_pk_bf16_f32 v109, v51, v55
    v_mul_f32 v48, v74, v44
    v_mul_f32 v49, v75, v45
    v_mul_f32 v50, v76, v44
    v_mul_f32 v51, v77, v45
    v_fmac_f32 v48, v76, v46
    v_fmac_f32 v49, v77, v47
    v_fmac_f32 v50, v74, v20
    v_fmac_f32 v51, v75, v21
    v_cvt_pk_bf16_f32 v98, v48, v48
    v_cvt_pk_bf16_f32 v102, v50, v50
    v_cvt_pk_bf16_f32 v106, v49, v49
    v_cvt_pk_bf16_f32 v110, v51, v51
    v_perm_b32 v128, v129, v128, s53
    v_perm_b32 v129, v131, v130, s53
    v_perm_b32 v130, v133, v132, s53
    v_perm_b32 v131, v135, v134, s53
    v_perm_b32 v132, v137, v136, s53
    v_perm_b32 v133, v139, v138, s53
    v_perm_b32 v134, v141, v140, s53
    v_perm_b32 v135, v143, v142, s53
    v_perm_b32 v144, v145, v144, s53
    v_perm_b32 v145, v147, v146, s53
    v_mfma_f32_16x16x32_bf16 v[112:115], v[128:131], v[192:195], 0
    v_perm_b32 v146, v149, v148, s53
    v_perm_b32 v147, v151, v150, s53
    v_mfma_f32_16x16x32_bf16 v[116:119], v[128:131], v[224:227], 0
    v_perm_b32 v148, v153, v152, s53
    v_perm_b32 v149, v155, v154, s53
    v_mfma_f32_16x16x32_bf16 v[112:115], v[132:135], v[196:199], v[112:115]
    v_perm_b32 v150, v157, v156, s53
    v_perm_b32 v151, v159, v158, s53
    v_mfma_f32_16x16x32_bf16 v[116:119], v[132:135], v[228:231], v[116:119]
    v_mfma_f32_32x32x16_bf16 v[128:143], v[96:99], v[78:81], 0
    v_perm_b32 v160, v161, v160, s53
    v_perm_b32 v161, v163, v162, s53
    v_mfma_f32_16x16x32_bf16 v[112:115], v[144:147], v[200:203], v[112:115]
    v_perm_b32 v162, v165, v164, s53
    v_perm_b32 v163, v167, v166, s53
    v_mfma_f32_16x16x32_bf16 v[116:119], v[144:147], v[232:235], v[116:119]
    v_perm_b32 v164, v169, v168, s53
    v_perm_b32 v165, v171, v170, s53
    v_mfma_f32_16x16x32_bf16 v[112:115], v[148:151], v[204:207], v[112:115]
    v_perm_b32 v166, v173, v172, s53
    v_perm_b32 v167, v175, v174, s53
    v_mfma_f32_16x16x32_bf16 v[116:119], v[148:151], v[236:239], v[116:119]
    v_mfma_f32_32x32x16_bf16 v[144:159], v[100:103], v[78:81], 0
    v_perm_b32 v176, v177, v176, s53
    v_perm_b32 v177, v179, v178, s53
    v_mfma_f32_16x16x32_bf16 v[112:115], v[160:163], v[208:211], v[112:115]
    v_perm_b32 v178, v181, v180, s53
    v_perm_b32 v179, v183, v182, s53
    v_mfma_f32_16x16x32_bf16 v[116:119], v[160:163], v[240:243], v[116:119]
    v_perm_b32 v180, v185, v184, s53
    v_perm_b32 v181, v187, v186, s53
    v_mfma_f32_16x16x32_bf16 v[112:115], v[164:167], v[212:215], v[112:115]
    v_perm_b32 v182, v189, v188, s53
    v_perm_b32 v183, v191, v190, s53
    v_mfma_f32_16x16x32_bf16 v[116:119], v[164:167], v[244:247], v[116:119]
    v_mfma_f32_32x32x16_bf16 v[160:175], v[104:107], v[78:81], 0
    s_nop 1
    v_mfma_f32_16x16x32_bf16 v[112:115], v[176:179], v[216:219], v[112:115]
    v_mfma_f32_16x16x32_bf16 v[116:119], v[176:179], v[248:251], v[116:119]
    v_mfma_f32_16x16x32_bf16 v[112:115], v[180:183], v[220:223], v[112:115]
    v_mfma_f32_16x16x32_bf16 v[116:119], v[180:183], v[252:255], v[116:119]
    v_mfma_f32_32x32x16_bf16 v[176:191], v[108:111], v[78:81], 0
    s_lshl_b32 s30, s3, 12
    s_add_u32 s30, s30, 65536
    v_and_b32_e64 v5, 15, v1
    v_lshl_add_u32 v5, v5, 2, s30
    v_lshrrev_b32_e64 v7, 4, v1
    v_lshl_add_u32 v5, v7, 9, v5
    ds_write_b32 v5, v112 offset:0
    ds_write_b32 v5, v113 offset:128
    ds_write_b32 v5, v114 offset:256
    ds_write_b32 v5, v115 offset:384
    ds_write_b32 v5, v116 offset:64
    ds_write_b32 v5, v117 offset:192
    ds_write_b32 v5, v118 offset:320
    ds_write_b32 v5, v119 offset:448
    v_add_u32 v28, 8972, v25
    v_add_u32 v29, 13608, v25
    v_add_u32 v30, 18244, v25
    v_add_u32 v31, 11020, v25
    v_add_u32 v36, 15656, v25
    v_add_u32 v37, 20292, v25
    s_waitcnt vmcnt(0)
    s_nop 0
    v_perm_b32 v128, v129, v128, s53
    v_perm_b32 v129, v131, v130, s53
    v_perm_b32 v130, v133, v132, s53
    v_perm_b32 v131, v135, v134, s53
    v_perm_b32 v132, v137, v136, s53
    v_perm_b32 v133, v139, v138, s53
    v_perm_b32 v134, v141, v140, s53
    v_perm_b32 v135, v143, v142, s53
    v_perm_b32 v144, v145, v144, s53
    v_perm_b32 v145, v147, v146, s53
    v_mfma_f32_16x16x32_bf16 v[120:123], v[128:131], v[192:195], 0
    v_perm_b32 v146, v149, v148, s53
    v_perm_b32 v147, v151, v150, s53
    v_mfma_f32_16x16x32_bf16 v[124:127], v[128:131], v[224:227], 0
    v_perm_b32 v148, v153, v152, s53
    v_perm_b32 v149, v155, v154, s53
    v_mfma_f32_16x16x32_bf16 v[120:123], v[132:135], v[196:199], v[120:123]
    v_perm_b32 v150, v157, v156, s53
    v_perm_b32 v151, v159, v158, s53
    v_mfma_f32_16x16x32_bf16 v[124:127], v[132:135], v[228:231], v[124:127]
    ds_write_b128 v25, v[88:91] offset:22880
    ds_write2_b64 v29, v[88:89], v[90:91] offset0:0 offset1:1
    ds_write2_b32 v28, v88, v89 offset0:0 offset1:1
    v_perm_b32 v160, v161, v160, s53
    v_perm_b32 v161, v163, v162, s53
    v_mfma_f32_16x16x32_bf16 v[120:123], v[144:147], v[200:203], v[120:123]
    v_perm_b32 v162, v165, v164, s53
    v_perm_b32 v163, v167, v166, s53
    v_mfma_f32_16x16x32_bf16 v[124:127], v[144:147], v[232:235], v[124:127]
    v_perm_b32 v164, v169, v168, s53
    v_perm_b32 v165, v171, v170, s53
    v_mfma_f32_16x16x32_bf16 v[120:123], v[148:151], v[204:207], v[120:123]
    v_perm_b32 v166, v173, v172, s53
    v_perm_b32 v167, v175, v174, s53
    v_mfma_f32_16x16x32_bf16 v[124:127], v[148:151], v[236:239], v[124:127]
    ds_write2_b32 v28, v90, v91 offset0:2 offset1:3
    ds_write2_b32 v30, v88, v89 offset0:0 offset1:1
    ds_write2_b32 v30, v90, v91 offset0:2 offset1:3
    v_perm_b32 v176, v177, v176, s53
    v_perm_b32 v177, v179, v178, s53
    v_mfma_f32_16x16x32_bf16 v[120:123], v[160:163], v[208:211], v[120:123]
    v_perm_b32 v178, v181, v180, s53
    v_perm_b32 v179, v183, v182, s53
    v_mfma_f32_16x16x32_bf16 v[124:127], v[160:163], v[240:243], v[124:127]
    v_perm_b32 v180, v185, v184, s53
    v_perm_b32 v181, v187, v186, s53
    v_mfma_f32_16x16x32_bf16 v[120:123], v[164:167], v[212:215], v[120:123]
    v_perm_b32 v182, v189, v188, s53
    v_perm_b32 v183, v191, v190, s53
    v_mfma_f32_16x16x32_bf16 v[124:127], v[164:167], v[244:247], v[124:127]
    ds_write_b128 v25, v[92:95] offset:24928
    ds_write2_b64 v36, v[92:93], v[94:95] offset0:0 offset1:1
    ds_write2_b32 v31, v92, v93 offset0:0 offset1:1
    s_nop 1
    v_mfma_f32_16x16x32_bf16 v[120:123], v[176:179], v[216:219], v[120:123]
    v_mfma_f32_16x16x32_bf16 v[124:127], v[176:179], v[248:251], v[124:127]
    v_mfma_f32_16x16x32_bf16 v[120:123], v[180:183], v[220:223], v[120:123]
    v_mfma_f32_16x16x32_bf16 v[124:127], v[180:183], v[252:255], v[124:127]
    ds_write2_b32 v31, v94, v95 offset0:2 offset1:3
    ds_write2_b32 v37, v92, v93 offset0:0 offset1:1
    ds_write2_b32 v37, v94, v95 offset0:2 offset1:3
    s_nop 7
    ds_write_b32 v5, v120 offset:2048
    ds_write_b32 v5, v121 offset:2176
    ds_write_b32 v5, v122 offset:2304
    ds_write_b32 v5, v123 offset:2432
    ds_write_b32 v5, v124 offset:2112
    ds_write_b32 v5, v125 offset:2240
    ds_write_b32 v5, v126 offset:2368
    ds_write_b32 v5, v127 offset:2496
    s_waitcnt lgkmcnt(0)
    s_barrier
    s_lshl_b32 s30, s42, 13
    s_add_u32 s30, s30, 65536
    v_lshl_add_u32 v3, v1, 2, s30
    s_mul_i32 s31, s42, 27136
    v_lshl_add_u32 v4, v1, 4, s31
    s_cmp_lg_u32 s41, 0
    s_cbranch_scc1 L_a_exp1
    s_nop 0
    ds_read_b32 v40, v3 offset:256
    ds_read_b32 v41, v3 offset:4352
    ds_read_b32 v42, v3 offset:2432
    ds_read_b32 v43, v3 offset:6528
    ds_read_b32 v44, v3 offset:260
    ds_read_b32 v45, v3 offset:4356
    ds_read_b32 v46, v3 offset:1916
    ds_read_b32 v47, v3 offset:6012
    ds_read_b32 v48, v3 offset:0
    ds_read_b32 v49, v3 offset:4096
    ds_read_b32 v50, v3 offset:1152
    ds_read_b32 v51, v3 offset:5248
    ds_read_b32 v52, v3 offset:1280
    ds_read_b32 v53, v3 offset:5376
    ds_read_b32 v54, v3 offset:1408
    ds_read_b32 v55, v3 offset:5504
    s_waitcnt lgkmcnt(10)
    v_add_f32 v40, v40, v41
    v_add_f32 v42, v42, v43
    v_add_f32 v44, v44, v45
    ds_read_b32 v56, v3 offset:1536
    ds_read_b32 v57, v3 offset:5632
    ds_read_b32 v58, v3 offset:1664
    ds_read_b32 v59, v3 offset:5760
    ds_read_b32 v60, v3 offset:1792
    ds_read_b32 v61, v3 offset:5888
    ds_read_b32 v62, v3 offset:1920
    ds_read_b32 v63, v3 offset:6016
    v_cvt_pk_bf16_f32 v68, v44, v44
    v_cvt_pk_bf16_f32 v69, v42, v42
    v_cvt_pk_bf16_f32 v70, v42, v40
    v_cvt_pk_bf16_f32 v71, v40, v40
    v_cvt_pk_bf16_f32 v64, v44, v42
    v_mov_b32 v65, v69
    v_mov_b32 v66, v71
    v_mov_b32_e64 v67, v71
    ds_write_b128 v4, v[68:71] offset:5360
    ds_write_b128 v4, v[64:67] offset:1136
    v_cmp_ne_u32 vcc, 0, v1
    s_waitcnt lgkmcnt(2)
    v_add_f32 v46, v46, v47
    v_add_f32 v48, v48, v49
    v_add_f32 v50, v50, v51
    v_add_f32 v52, v52, v53
    v_add_f32 v54, v54, v55
    v_add_f32 v56, v56, v57
    v_add_f32 v58, v58, v59
    v_add_f32 v60, v60, v61
    v_add_f32 v62, v62, v63
    v_cndmask_b32 v46, 0, v46, vcc
    v_cvt_pk_bf16_f32 v76, v62, v60
    v_cvt_pk_bf16_f32 v72, v60, v58
    v_cvt_pk_bf16_f32 v77, v58, v56
    v_cvt_pk_bf16_f32 v73, v56, v54
    v_cvt_pk_bf16_f32 v78, v54, v52
    v_cvt_pk_bf16_f32 v74, v52, v50
    v_cvt_pk_bf16_f32 v79, v50, v48
    v_cvt_pk_bf16_f32 v75, v48, v46
    s_mov_b32 exec_hi, 0
    ds_write_b128 v4, v[76:79] offset:4336
    ds_write_b128 v4, v[72:75] offset:112
    s_mov_b64 exec, -1
    s_branch L_a_exp2
L_a_exp1:
    s_nop 0
    ds_read_b32 v40, v3 offset:512
    ds_read_b32 v41, v3 offset:4608
    ds_read_b32 v42, v3 offset:516
    ds_read_b32 v43, v3 offset:4612
    ds_read_b32 v44, v3 offset:768
    ds_read_b32 v45, v3 offset:4864
    ds_read_b32 v46, v3 offset:772
    ds_read_b32 v47, v3 offset:4868
    v_add_u32 v22, 1916, v3
    v_cmp_eq_u32 vcc, 0, v1
    v_and_b32 v23, 1, v1
    s_nop 0
    v_cndmask_b32 v22, v3, v22, vcc
    ds_read_b32 v48, v3 offset:128
    ds_read_b32 v49, v3 offset:4224
    ds_read_b32 v50, v3 offset:2048
    ds_read_b32 v51, v3 offset:6144
    ds_read_b32 v52, v3 offset:2176
    ds_read_b32 v53, v3 offset:6272
    v_cmp_eq_u32 vcc, 0, v23
    s_waitcnt lgkmcnt(6)
    v_add_f32 v40, v40, v41
    v_add_f32 v42, v42, v43
    v_add_f32 v44, v44, v45
    v_add_f32 v46, v46, v47
    ds_read_b32 v54, v3 offset:2304
    ds_read_b32 v55, v3 offset:6400
    ds_read_b32 v56, v3 offset:132
    ds_read_b32 v57, v3 offset:4228
    ds_read_b32 v58, v22 offset:128
    ds_read_b32 v59, v22 offset:4224
    v_cndmask_b32_e64 v41, v42, v40, vcc
    v_cvt_pk_bf16_f32 v68, v42, v42
    v_cvt_pk_bf16_f32 v69, v42, v41
    v_cvt_pk_bf16_f32 v70, v40, v40
    v_mov_b32 v71, v70
    v_mov_b32 v64, v68
    v_cvt_pk_bf16_f32 v65, v41, v40
    v_mov_b32 v66, v70
    v_mov_b32 v67, v70
    ds_write_b128 v4, v[68:71] offset:6384
    ds_write_b128 v4, v[64:67] offset:2160
    v_cndmask_b32_e64 v45, v46, v44, vcc
    v_cvt_pk_bf16_f32 v76, v46, v46
    v_cvt_pk_bf16_f32 v77, v46, v45
    v_cvt_pk_bf16_f32 v78, v44, v44
    v_mov_b32 v79, v78
    v_mov_b32 v72, v76
    v_cvt_pk_bf16_f32 v73, v45, v44
    v_mov_b32 v74, v78
    v_mov_b32 v75, v78
    ds_write_b128 v4, v[76:79] offset:7408
    ds_write_b128 v4, v[72:75] offset:3184
    s_waitcnt lgkmcnt(4)
    v_add_f32 v48, v48, v49
    v_add_f32 v50, v50, v51
    v_add_f32 v52, v52, v53
    v_add_f32 v54, v54, v55
    v_add_f32 v56, v56, v57
    v_add_f32_e64 v58, v58, v59
    v_cvt_pk_bf16_f32 v84, v56, v54
    v_cvt_pk_bf16_f32 v85, v52, v52
    v_cvt_pk_bf16_f32 v86, v52, v50
    v_cvt_pk_bf16_f32 v87, v48, v48
    v_cvt_pk_bf16_f32 v80, v54, v52
    v_mov_b32_e64 v81, v85
    v_cvt_pk_bf16_f32 v82, v50, v48
    v_cvt_pk_bf16_f32 v83, v48, v58
    s_mov_b32 exec_hi, 0
    ds_write_b128 v4, v[84:87] offset:4848
    ds_write_b128 v4, v[80:83] offset:624
    s_mov_b64 exec, -1
L_a_exp2:
    v_and_b32 v22, 15, v1
    v_lshrrev_b32 v23, 4, v1
    v_and_b32_e64 v4, 1, v22
    v_mul_u32_u24 v4, 4224, v4
    v_lshrrev_b32 v5, 1, v22
    v_sub_u32 v5, v5, v23
    v_add_u32_e64 v5, 19, v5
    v_lshl_add_u32 v4, v5, 4, v4
    s_lshl_b32 s30, s41, 8
    s_sub_u32 s32, s31, s30
    v_add_u32 v4, s32, v4
    v_and_b32 v5, 3, v22
    v_mul_u32_u24 v5, 4640, v5
    v_lshrrev_b32_e64 v22, 2, v22
    v_lshl_add_u32 v23, v22, 3, v23
    v_lshl_add_u32 v5, v23, 4, v5
    s_add_u32 s32, s31, s30
    s_add_u32 s32, s32, 8576
    v_add_u32_e64 v5, s32, v5
    s_lshl_b32 s48, s2, 7
    s_add_u32 s48, s48, 0x910000
    s_mov_b32 s49, 0x910000
    s_waitcnt lgkmcnt(0)
    s_barrier
    s_setprio 1
    s_nop 0
    ds_read_b128 v[128:131], v4 offset:192
    ds_read_b128 v[160:163], v5 offset:0
    ds_read_b128 v[132:135], v4 offset:704
    ds_read_b128 v[164:167], v5 offset:512
    ds_read_b128 v[136:139], v4 offset:1216
    ds_read_b128 v[168:171], v5 offset:1024
    ds_read_b128 v[140:143], v4 offset:1728
    ds_read_b128 v[172:175], v5 offset:1536
    ds_read_b128 v[144:147], v4 offset:2240
    ds_read_b128 v[176:179], v5 offset:2048
    ds_read_b128 v[148:151], v4 offset:2752
    ds_read_b128 v[180:183], v5 offset:2560
    ds_read_b128 v[152:155], v4 offset:3264
    ds_read_b128 v[184:187], v5 offset:3072
    ds_read_b128 v[156:159], v4 offset:3776
    ds_read_b128 v[188:191], v5 offset:3584
    s_waitcnt lgkmcnt(14)
    v_mfma_f32_16x16x32_bf16 v[96:99], v[128:131], v[160:163], 0
    s_waitcnt lgkmcnt(12)
    v_mfma_f32_16x16x32_bf16 v[100:103], v[132:135], v[160:163], 0
    v_mfma_f32_16x16x32_bf16 v[104:107], v[132:135], v[164:167], 0
    v_mfma_f32_16x16x32_bf16 v[100:103], v[128:131], v[164:167], v[100:103]
    s_waitcnt lgkmcnt(10)
    v_mfma_f32_16x16x32_bf16 v[104:107], v[136:139], v[160:163], v[104:107]
    v_mfma_f32_16x16x32_bf16 v[108:111], v[136:139], v[164:167], 0
    v_mfma_f32_16x16x32_bf16 v[112:115], v[136:139], v[168:171], 0
    v_mfma_f32_16x16x32_bf16 v[104:107], v[128:131], v[168:171], v[104:107]
    v_mfma_f32_16x16x32_bf16 v[108:111], v[132:135], v[168:171], v[108:111]
    s_waitcnt lgkmcnt(8)
    v_mfma_f32_16x16x32_bf16 v[108:111], v[140:143], v[160:163], v[108:111]
    v_mfma_f32_16x16x32_bf16 v[112:115], v[140:143], v[164:167], v[112:115]
    v_mfma_f32_16x16x32_bf16 v[116:119], v[140:143], v[168:171], 0
    v_mfma_f32_16x16x32_bf16 v[120:123], v[140:143], v[172:175], 0
    v_mfma_f32_16x16x32_bf16 v[108:111], v[128:131], v[172:175], v[108:111]
    v_mfma_f32_16x16x32_bf16 v[112:115], v[132:135], v[172:175], v[112:115]
    v_mfma_f32_16x16x32_bf16 v[116:119], v[136:139], v[172:175], v[116:119]
    s_waitcnt lgkmcnt(6)
    s_nop 0
    v_mfma_f32_16x16x32_bf16 v[112:115], v[144:147], v[160:163], v[112:115]
    v_mfma_f32_16x16x32_bf16 v[116:119], v[144:147], v[164:167], v[116:119]
    ds_read_b128 v[192:195], v4 offset:128
    ds_read_b128 v[224:227], v5 offset:64
    v_mfma_f32_16x16x32_bf16 v[120:123], v[144:147], v[168:171], v[120:123]
    v_mfma_f32_16x16x32_bf16 v[124:127], v[144:147], v[172:175], 0
    ds_read_b128 v[196:199], v4 offset:640
    ds_read_b128 v[228:231], v5 offset:576
    v_mfma_f32_16x16x32_bf16 v[112:115], v[128:131], v[176:179], v[112:115]
    v_mfma_f32_16x16x32_bf16 v[116:119], v[132:135], v[176:179], v[116:119]
    ds_read_b128 v[200:203], v4 offset:1152
    ds_read_b128 v[232:235], v5 offset:1088
    v_mfma_f32_16x16x32_bf16 v[120:123], v[136:139], v[176:179], v[120:123]
    v_mfma_f32_16x16x32_bf16 v[124:127], v[140:143], v[176:179], v[124:127]
    ds_read_b128 v[204:207], v4 offset:1664
    ds_read_b128 v[236:239], v5 offset:1600
    s_waitcnt lgkmcnt(12)
    s_nop 0
    v_mfma_f32_16x16x32_bf16 v[116:119], v[148:151], v[160:163], v[116:119]
    v_mfma_f32_16x16x32_bf16 v[120:123], v[148:151], v[164:167], v[120:123]
    ds_read_b128 v[208:211], v4 offset:2176
    ds_read_b128 v[240:243], v5 offset:2112
    v_mfma_f32_16x16x32_bf16 v[124:127], v[148:151], v[168:171], v[124:127]
    v_mfma_f32_16x16x32_bf16 v[116:119], v[128:131], v[180:183], v[116:119]
    ds_read_b128 v[212:215], v4 offset:2688
    ds_read_b128 v[244:247], v5 offset:2624
    v_mfma_f32_16x16x32_bf16 v[120:123], v[132:135], v[180:183], v[120:123]
    v_mfma_f32_16x16x32_bf16 v[124:127], v[136:139], v[180:183], v[124:127]
    ds_read_b128 v[216:219], v4 offset:3200
    ds_read_b128 v[248:251], v5 offset:3136
    s_waitcnt lgkmcnt(15)
    v_mfma_f32_16x16x32_bf16 v[120:123], v[152:155], v[160:163], v[120:123]
    v_mfma_f32_16x16x32_bf16 v[124:127], v[152:155], v[164:167], v[124:127]
    ds_read_b128 v[220:223], v4 offset:3712
    ds_read_b128 v[252:255], v5 offset:3648
    v_mfma_f32_16x16x32_bf16 v[120:123], v[128:131], v[184:187], v[120:123]
    v_mfma_f32_16x16x32_bf16 v[124:127], v[132:135], v[184:187], v[124:127]
    s_waitcnt lgkmcnt(15)
    v_mfma_f32_16x16x32_bf16 v[124:127], v[156:159], v[160:163], v[124:127]
    v_mfma_f32_16x16x32_bf16 v[124:127], v[128:131], v[188:191], v[124:127]
    s_waitcnt lgkmcnt(0)
    s_nop 0
    v_mfma_f32_16x16x32_bf16 v[96:99], v[192:195], v[224:227], v[96:99]
    v_mfma_f32_16x16x32_bf16 v[100:103], v[196:199], v[224:227], v[100:103]
    ds_read_b128 v[128:131], v4 offset:64
    v_mfma_f32_16x16x32_bf16 v[104:107], v[196:199], v[228:231], v[104:107]
    v_mfma_f32_16x16x32_bf16 v[100:103], v[192:195], v[228:231], v[100:103]
    ds_read_b128 v[160:163], v5 offset:128
    v_mfma_f32_16x16x32_bf16 v[104:107], v[200:203], v[224:227], v[104:107]
    v_mfma_f32_16x16x32_bf16 v[108:111], v[200:203], v[228:231], v[108:111]
    ds_read_b128 v[132:135], v4 offset:576
    v_mfma_f32_16x16x32_bf16 v[112:115], v[200:203], v[232:235], v[112:115]
    v_mfma_f32_16x16x32_bf16 v[104:107], v[192:195], v[232:235], v[104:107]
    ds_read_b128 v[164:167], v5 offset:640
    v_mfma_f32_16x16x32_bf16 v[108:111], v[196:199], v[232:235], v[108:111]
    v_mfma_f32_16x16x32_bf16 v[108:111], v[204:207], v[224:227], v[108:111]
    ds_read_b128 v[136:139], v4 offset:1088
    v_mfma_f32_16x16x32_bf16 v[112:115], v[204:207], v[228:231], v[112:115]
    v_mfma_f32_16x16x32_bf16 v[116:119], v[204:207], v[232:235], v[116:119]
    ds_read_b128 v[168:171], v5 offset:1152
    v_mfma_f32_16x16x32_bf16 v[120:123], v[204:207], v[236:239], v[120:123]
    v_mfma_f32_16x16x32_bf16 v[108:111], v[192:195], v[236:239], v[108:111]
    ds_read_b128 v[140:143], v4 offset:1600
    v_mfma_f32_16x16x32_bf16 v[112:115], v[196:199], v[236:239], v[112:115]
    v_mfma_f32_16x16x32_bf16 v[116:119], v[200:203], v[236:239], v[116:119]
    ds_read_b128 v[172:175], v5 offset:1664
    v_mfma_f32_16x16x32_bf16 v[112:115], v[208:211], v[224:227], v[112:115]
    v_mfma_f32_16x16x32_bf16 v[116:119], v[208:211], v[228:231], v[116:119]
    ds_read_b128 v[144:147], v4 offset:2112
    v_mfma_f32_16x16x32_bf16 v[120:123], v[208:211], v[232:235], v[120:123]
    v_mfma_f32_16x16x32_bf16 v[124:127], v[208:211], v[236:239], v[124:127]
    ds_read_b128 v[176:179], v5 offset:2176
    v_mfma_f32_16x16x32_bf16 v[112:115], v[192:195], v[240:243], v[112:115]
    v_mfma_f32_16x16x32_bf16 v[116:119], v[196:199], v[240:243], v[116:119]
    ds_read_b128 v[148:151], v4 offset:2624
    v_mfma_f32_16x16x32_bf16 v[120:123], v[200:203], v[240:243], v[120:123]
    v_mfma_f32_16x16x32_bf16 v[124:127], v[204:207], v[240:243], v[124:127]
    ds_read_b128 v[180:183], v5 offset:2688
    v_mfma_f32_16x16x32_bf16 v[116:119], v[212:215], v[224:227], v[116:119]
    v_mfma_f32_16x16x32_bf16 v[120:123], v[212:215], v[228:231], v[120:123]
    ds_read_b128 v[152:155], v4 offset:3136
    v_mfma_f32_16x16x32_bf16 v[124:127], v[212:215], v[232:235], v[124:127]
    v_mfma_f32_16x16x32_bf16 v[116:119], v[192:195], v[244:247], v[116:119]
    ds_read_b128 v[184:187], v5 offset:3200
    v_mfma_f32_16x16x32_bf16 v[120:123], v[196:199], v[244:247], v[120:123]
    v_mfma_f32_16x16x32_bf16 v[124:127], v[200:203], v[244:247], v[124:127]
    ds_read_b128 v[156:159], v4 offset:3648
    v_mfma_f32_16x16x32_bf16 v[120:123], v[216:219], v[224:227], v[120:123]
    v_mfma_f32_16x16x32_bf16 v[124:127], v[216:219], v[228:231], v[124:127]
    ds_read_b128 v[188:191], v5 offset:3712
    v_mfma_f32_16x16x32_bf16 v[120:123], v[192:195], v[248:251], v[120:123]
    v_mfma_f32_16x16x32_bf16 v[124:127], v[196:199], v[248:251], v[124:127]
    v_mfma_f32_16x16x32_bf16 v[124:127], v[220:223], v[224:227], v[124:127]
    v_mfma_f32_16x16x32_bf16 v[124:127], v[192:195], v[252:255], v[124:127]
    s_waitcnt lgkmcnt(0)
    s_nop 0
    v_mfma_f32_16x16x32_bf16 v[96:99], v[128:131], v[160:163], v[96:99]
    v_mfma_f32_16x16x32_bf16 v[100:103], v[132:135], v[160:163], v[100:103]
    ds_read_b128 v[192:195], v4 offset:0
    v_mfma_f32_16x16x32_bf16 v[104:107], v[132:135], v[164:167], v[104:107]
    v_mfma_f32_16x16x32_bf16 v[100:103], v[128:131], v[164:167], v[100:103]
    ds_read_b128 v[224:227], v5 offset:192
    v_mfma_f32_16x16x32_bf16 v[104:107], v[136:139], v[160:163], v[104:107]
    v_mfma_f32_16x16x32_bf16 v[108:111], v[136:139], v[164:167], v[108:111]
    ds_read_b128 v[196:199], v4 offset:512
    v_mfma_f32_16x16x32_bf16 v[112:115], v[136:139], v[168:171], v[112:115]
    v_mfma_f32_16x16x32_bf16 v[104:107], v[128:131], v[168:171], v[104:107]
    ds_read_b128 v[228:231], v5 offset:704
    v_mfma_f32_16x16x32_bf16 v[108:111], v[132:135], v[168:171], v[108:111]
    v_mfma_f32_16x16x32_bf16 v[108:111], v[140:143], v[160:163], v[108:111]
    ds_read_b128 v[200:203], v4 offset:1024
    v_mfma_f32_16x16x32_bf16 v[112:115], v[140:143], v[164:167], v[112:115]
    v_mfma_f32_16x16x32_bf16 v[116:119], v[140:143], v[168:171], v[116:119]
    ds_read_b128 v[232:235], v5 offset:1216
    v_mfma_f32_16x16x32_bf16 v[120:123], v[140:143], v[172:175], v[120:123]
    v_mfma_f32_16x16x32_bf16 v[108:111], v[128:131], v[172:175], v[108:111]
    ds_read_b128 v[204:207], v4 offset:1536
    v_mfma_f32_16x16x32_bf16 v[112:115], v[132:135], v[172:175], v[112:115]
    v_mfma_f32_16x16x32_bf16 v[116:119], v[136:139], v[172:175], v[116:119]
    ds_read_b128 v[236:239], v5 offset:1728
    v_mfma_f32_16x16x32_bf16 v[112:115], v[144:147], v[160:163], v[112:115]
    v_mfma_f32_16x16x32_bf16 v[116:119], v[144:147], v[164:167], v[116:119]
    ds_read_b128 v[208:211], v4 offset:2048
    v_mfma_f32_16x16x32_bf16 v[120:123], v[144:147], v[168:171], v[120:123]
    v_mfma_f32_16x16x32_bf16 v[124:127], v[144:147], v[172:175], v[124:127]
    ds_read_b128 v[240:243], v5 offset:2240
    v_mfma_f32_16x16x32_bf16 v[112:115], v[128:131], v[176:179], v[112:115]
    v_mfma_f32_16x16x32_bf16 v[116:119], v[132:135], v[176:179], v[116:119]
    ds_read_b128 v[212:215], v4 offset:2560
    v_mfma_f32_16x16x32_bf16 v[120:123], v[136:139], v[176:179], v[120:123]
    v_mfma_f32_16x16x32_bf16 v[124:127], v[140:143], v[176:179], v[124:127]
    ds_read_b128 v[244:247], v5 offset:2752
    v_mfma_f32_16x16x32_bf16 v[116:119], v[148:151], v[160:163], v[116:119]
    v_mfma_f32_16x16x32_bf16 v[120:123], v[148:151], v[164:167], v[120:123]
    ds_read_b128 v[216:219], v4 offset:3072
    v_mfma_f32_16x16x32_bf16 v[124:127], v[148:151], v[168:171], v[124:127]
    v_mfma_f32_16x16x32_bf16 v[116:119], v[128:131], v[180:183], v[116:119]
    ds_read_b128 v[248:251], v5 offset:3264
    v_mfma_f32_16x16x32_bf16 v[120:123], v[132:135], v[180:183], v[120:123]
    v_mfma_f32_16x16x32_bf16 v[124:127], v[136:139], v[180:183], v[124:127]
    ds_read_b128 v[220:223], v4 offset:3584
    v_mfma_f32_16x16x32_bf16 v[120:123], v[152:155], v[160:163], v[120:123]
    v_mfma_f32_16x16x32_bf16 v[124:127], v[152:155], v[164:167], v[124:127]
    ds_read_b128 v[252:255], v5 offset:3776
    v_mfma_f32_16x16x32_bf16 v[120:123], v[128:131], v[184:187], v[120:123]
    v_mfma_f32_16x16x32_bf16 v[124:127], v[132:135], v[184:187], v[124:127]
    v_mfma_f32_16x16x32_bf16 v[124:127], v[156:159], v[160:163], v[124:127]
    v_mfma_f32_16x16x32_bf16 v[124:127], v[128:131], v[188:191], v[124:127]
    s_waitcnt lgkmcnt(0)
    v_mfma_f32_16x16x32_bf16 v[96:99], v[192:195], v[224:227], v[96:99]
    v_mfma_f32_16x16x32_bf16 v[100:103], v[196:199], v[224:227], v[100:103]
    v_mfma_f32_16x16x32_bf16 v[104:107], v[196:199], v[228:231], v[104:107]
    v_mfma_f32_16x16x32_bf16 v[100:103], v[192:195], v[228:231], v[100:103]
    v_mfma_f32_16x16x32_bf16 v[104:107], v[200:203], v[224:227], v[104:107]
    v_mfma_f32_16x16x32_bf16 v[108:111], v[200:203], v[228:231], v[108:111]
    v_mfma_f32_16x16x32_bf16 v[112:115], v[200:203], v[232:235], v[112:115]
    v_mfma_f32_16x16x32_bf16 v[104:107], v[192:195], v[232:235], v[104:107]
    v_mfma_f32_16x16x32_bf16 v[108:111], v[196:199], v[232:235], v[108:111]
    v_mfma_f32_16x16x32_bf16 v[108:111], v[204:207], v[224:227], v[108:111]
    v_mfma_f32_16x16x32_bf16 v[112:115], v[204:207], v[228:231], v[112:115]
    v_mfma_f32_16x16x32_bf16 v[116:119], v[204:207], v[232:235], v[116:119]
    v_mfma_f32_16x16x32_bf16 v[120:123], v[204:207], v[236:239], v[120:123]
    v_mfma_f32_16x16x32_bf16 v[108:111], v[192:195], v[236:239], v[108:111]
    v_mfma_f32_16x16x32_bf16 v[112:115], v[196:199], v[236:239], v[112:115]
    v_mfma_f32_16x16x32_bf16 v[116:119], v[200:203], v[236:239], v[116:119]
    v_mfma_f32_16x16x32_bf16 v[112:115], v[208:211], v[224:227], v[112:115]
    v_mfma_f32_16x16x32_bf16 v[116:119], v[208:211], v[228:231], v[116:119]
    v_mfma_f32_16x16x32_bf16 v[120:123], v[208:211], v[232:235], v[120:123]
    v_mfma_f32_16x16x32_bf16 v[124:127], v[208:211], v[236:239], v[124:127]
    v_mfma_f32_16x16x32_bf16 v[112:115], v[192:195], v[240:243], v[112:115]
    v_mfma_f32_16x16x32_bf16 v[116:119], v[196:199], v[240:243], v[116:119]
    v_mfma_f32_16x16x32_bf16 v[120:123], v[200:203], v[240:243], v[120:123]
    v_mfma_f32_16x16x32_bf16 v[124:127], v[204:207], v[240:243], v[124:127]
    v_mfma_f32_16x16x32_bf16 v[116:119], v[212:215], v[224:227], v[116:119]
    v_mfma_f32_16x16x32_bf16 v[120:123], v[212:215], v[228:231], v[120:123]
    v_mfma_f32_16x16x32_bf16 v[124:127], v[212:215], v[232:235], v[124:127]
    v_mfma_f32_16x16x32_bf16 v[116:119], v[192:195], v[244:247], v[116:119]
    v_mfma_f32_16x16x32_bf16 v[120:123], v[196:199], v[244:247], v[120:123]
    v_mfma_f32_16x16x32_bf16 v[124:127], v[200:203], v[244:247], v[124:127]
    v_mfma_f32_16x16x32_bf16 v[120:123], v[216:219], v[224:227], v[120:123]
    v_mfma_f32_16x16x32_bf16 v[124:127], v[216:219], v[228:231], v[124:127]
    v_mfma_f32_16x16x32_bf16 v[120:123], v[192:195], v[248:251], v[120:123]
    v_mfma_f32_16x16x32_bf16 v[124:127], v[196:199], v[248:251], v[124:127]
    v_mfma_f32_16x16x32_bf16 v[124:127], v[220:223], v[224:227], v[124:127]
    v_mfma_f32_16x16x32_bf16 v[124:127], v[192:195], v[252:255], v[124:127]
    s_setprio 3
    s_lshl_b32 s30, s3, 12
    s_add_u32 s30, s30, 65536
    v_lshl_add_u32 v3, v1, 4, s30
    v_xor_b32 v4, 0x1000, v3
    v_bfe_u32 v5, v1, 2, 2
    v_lshlrev_b32 v5, 13, v5
    v_lshrrev_b32_e64 v22, 4, v1
    v_lshl_add_u32 v5, v22, 5, v5
    v_and_b32_e64 v22, 3, v1
    v_lshl_add_u32 v5, v22, 3, v5
    s_lshl_b32 s50, s37, 18
    s_lshl_b32 s30, s38, 1
    s_add_u32 s30, s30, s42
    s_lshl_b32 s30, s30, 7
    s_add_u32 s50, s50, s30
    s_lshl_b32 s30, s41, 17
    s_add_u32 s50, s50, s30
    s_add_u32 s50, s50, 0x200000
    s_cmp_lg_u32 s41, 0
    s_cbranch_scc1 L_a_red1
    ds_write_b128 v3, v[112:115] offset:0
    ds_write_b128 v3, v[116:119] offset:1024
    ds_write_b128 v3, v[120:123] offset:2048
    ds_write_b128 v3, v[124:127] offset:3072
    s_waitcnt lgkmcnt(0)
    s_barrier
    ds_read_b128 v[40:43], v4 offset:0
    ds_read_b128 v[44:47], v4 offset:1024
    ds_read_b128 v[48:51], v4 offset:2048
    ds_read_b128 v[52:55], v4 offset:3072
    s_waitcnt lgkmcnt(3)
    v_add_f32 v40, v40, v96
    v_add_f32 v41, v41, v97
    v_add_f32 v42, v42, v98
    v_add_f32 v43, v43, v99
    v_cvt_pk_bf16_f32 v56, v40, v41
    v_cvt_pk_bf16_f32 v57, v42, v43
    buffer_store_dwordx2 v[56:57], v5, s[8:11], s50 offen sc1
    s_add_u32 s50, s50, 32768
    s_waitcnt lgkmcnt(2)
    v_add_f32 v44, v44, v100
    v_add_f32 v45, v45, v101
    v_add_f32 v46, v46, v102
    v_add_f32_e64 v47, v47, v103
    v_cvt_pk_bf16_f32 v58, v44, v45
    v_cvt_pk_bf16_f32 v59, v46, v47
    buffer_store_dwordx2 v[58:59], v5, s[8:11], s50 offen sc1
    s_add_u32 s50, s50, 32768
    s_waitcnt lgkmcnt(1)
    v_add_f32 v48, v48, v104
    v_add_f32 v49, v49, v105
    v_add_f32 v50, v50, v106
    v_add_f32_e64 v51, v51, v107
    v_cvt_pk_bf16_f32 v60, v48, v49
    v_cvt_pk_bf16_f32 v61, v50, v51
    buffer_store_dwordx2 v[60:61], v5, s[8:11], s50 offen sc1
    s_add_u32 s50, s50, 32768
    s_waitcnt lgkmcnt(0)
    v_add_f32 v52, v52, v108
    v_add_f32 v53, v53, v109
    v_add_f32 v54, v54, v110
    v_add_f32_e64 v55, v55, v111
    v_cvt_pk_bf16_f32 v62, v52, v53
    v_cvt_pk_bf16_f32 v63, v54, v55
    buffer_store_dwordx2 v[62:63], v5, s[8:11], s50 offen sc1
    s_branch L_a_red2
L_a_red1:
    ds_write_b128 v3, v[96:99] offset:0
    ds_write_b128 v3, v[100:103] offset:1024
    ds_write_b128 v3, v[104:107] offset:2048
    ds_write_b128 v3, v[108:111] offset:3072
    s_waitcnt lgkmcnt(0)
    s_barrier
    ds_read_b128 v[40:43], v4 offset:0
    ds_read_b128 v[44:47], v4 offset:1024
    ds_read_b128 v[48:51], v4 offset:2048
    ds_read_b128 v[52:55], v4 offset:3072
    s_waitcnt lgkmcnt(3)
    v_add_f32 v40, v40, v112
    v_add_f32 v41, v41, v113
    v_add_f32 v42, v42, v114
    v_add_f32 v43, v43, v115
    v_cvt_pk_bf16_f32 v56, v40, v41
    v_cvt_pk_bf16_f32 v57, v42, v43
    buffer_store_dwordx2 v[56:57], v5, s[8:11], s50 offen sc1
    s_add_u32 s50, s50, 32768
    s_waitcnt lgkmcnt(2)
    v_add_f32 v44, v44, v116
    v_add_f32 v45, v45, v117
    v_add_f32 v46, v46, v118
    v_add_f32_e64 v47, v47, v119
    v_cvt_pk_bf16_f32 v58, v44, v45
    v_cvt_pk_bf16_f32 v59, v46, v47
    buffer_store_dwordx2 v[58:59], v5, s[8:11], s50 offen sc1
    s_add_u32 s50, s50, 32768
    s_waitcnt lgkmcnt(1)
    v_add_f32 v48, v48, v120
    v_add_f32 v49, v49, v121
    v_add_f32 v50, v50, v122
    v_add_f32_e64 v51, v51, v123
    v_cvt_pk_bf16_f32 v60, v48, v49
    v_cvt_pk_bf16_f32 v61, v50, v51
    buffer_store_dwordx2 v[60:61], v5, s[8:11], s50 offen sc1
    s_add_u32 s50, s50, 32768
    s_waitcnt lgkmcnt(0)
    v_add_f32 v52, v52, v124
    v_add_f32 v53, v53, v125
    v_add_f32 v54, v54, v126
    v_add_f32_e64 v55, v55, v127
    v_cvt_pk_bf16_f32 v62, v52, v53
    v_cvt_pk_bf16_f32 v63, v54, v55
    buffer_store_dwordx2 v[62:63], v5, s[8:11], s50 offen sc1
L_a_red2:
    v_lshl_add_u32 v22, v1, 1, s45
    ds_read_u16 v64, v22 offset:0
    ds_read_u16 v65, v22 offset:128
    ds_read_u16 v66, v22 offset:256
    ds_read_u16 v67, v22 offset:384
    ds_read_u16 v68, v22 offset:512
    ds_read_u16 v69, v22 offset:640
    ds_read_u16 v70, v22 offset:768
    ds_read_u16 v71, v22 offset:896
    ds_read_u16 v72, v22 offset:1056
    ds_read_u16 v73, v22 offset:1184
    ds_read_u16 v74, v22 offset:1312
    ds_read_u16 v75, v22 offset:1440
    ds_read_u16 v76, v22 offset:1568
    ds_read_u16 v77, v22 offset:1696
    ds_read_u16 v78, v22 offset:1824
    ds_read_u16 v79, v22 offset:1952
    v_lshlrev_b32 v18, 16, v18
    s_waitcnt lgkmcnt(0)
    v_lshlrev_b32 v64, 16, v64
    v_lshlrev_b32 v65, 16, v65
    v_lshlrev_b32 v66, 16, v66
    v_lshlrev_b32 v67, 16, v67
    v_lshlrev_b32 v68, 16, v68
    v_lshlrev_b32 v69, 16, v69
    v_lshlrev_b32 v70, 16, v70
    v_lshlrev_b32 v71, 16, v71
    v_lshlrev_b32 v72, 16, v72
    v_lshlrev_b32 v73, 16, v73
    v_lshlrev_b32 v74, 16, v74
    v_lshlrev_b32 v75, 16, v75
    v_lshlrev_b32 v76, 16, v76
    v_lshlrev_b32 v77, 16, v77
    v_lshlrev_b32 v78, 16, v78
    v_lshlrev_b32 v79, 16, v79
    v_lshlrev_b32 v20, 4, v0
    s_lshl_b32 s50, s2, 13
    s_add_u32 s50, s50, 0x200000
    s_add_u32 s51, s50, 4096
    v_lshrrev_b32_e64 v21, 3, v0
    v_mul_u32_u24 v21, 144, v21
    v_and_b32_e64 v22, 7, v0
    v_lshl_add_u32 v21, v22, 4, v21
    v_mul_u32_u24 v3, 144, v1
    s_lshl_b32 s30, s3, 5
    v_add_u32 v3, s30, v3
    v_lshlrev_b32_e64 v4, 2, v1
    s_lshl_b32 s30, s40, 2
    s_add_u32 s30, s30, s3
    s_mul_i32 s52, s30, 57344
    s_lshl_b32 s30, s39, 8
    s_add_u32 s52, s52, s30
    s_waitcnt vmcnt(0)
    s_barrier
    s_cmp_lg_u32 s3, 0
    s_cbranch_scc1 L_pf1728
    v_mov_b32 v22, s28
    s_mov_b64 exec, 1
    buffer_store_dword v22, v2, s[8:11], s48 offen sc1
    s_mov_b64 exec, -1
L_pf1728:
    s_cmp_lg_u32 s3, 0
    s_cbranch_scc1 L_a2_np
    s_mov_b32 exec_hi, 0
    s_mov_b32 exec_lo, 0xffffffff
    s_branch L_a3_p1
L_a3_poll:
    s_sleep 2
L_a3_p1:
    buffer_load_dword v9, v19, s[8:11], s49 offen sc1
    s_add_u32 s29, s29, 1
    s_cmp_gt_u32 s29, 131072
    s_cbranch_scc1 L_end
    s_waitcnt vmcnt(0)
    v_cmp_ne_u32 vcc, s28, v9
    s_cbranch_vccnz L_a3_poll
    s_mov_b64 exec, -1
L_a2_np:
    s_barrier
    buffer_load_dwordx4 v[24:27], v20, s[8:11], s50 offen sc1
    buffer_load_dwordx4 v[28:31], v20, s[8:11], s51 offen sc1
    s_waitcnt vmcnt(0)
    ds_write_b128 v21, v[24:27] offset:0
    ds_write_b128 v21, v[28:31] offset:4608
    s_waitcnt lgkmcnt(0)
    s_barrier
    ds_read_b128 v[40:43], v3 offset:0
    ds_read_b128 v[44:47], v3 offset:16
    s_waitcnt lgkmcnt(1)
    v_lshlrev_b32 v48, 16, v40
    v_and_b32 v49, s34, v40
    v_fmac_f32 v48, v18, v64
    v_fmac_f32_e64 v49, v18, v65
    s_add_u32 s30, s52, 0
    buffer_store_dword v48, v4, s[12:15], s30 offen sc1
    buffer_store_dword v49, v4, s[12:15], s30 offen offset:3584 sc1
    v_lshlrev_b32 v50, 16, v41
    v_and_b32 v51, s34, v41
    v_fmac_f32 v50, v18, v72
    v_fmac_f32 v51, v18, v73
    s_add_u32 s30, s52, 28672
    buffer_store_dword v50, v4, s[12:15], s30 offen sc1
    buffer_store_dword v51, v4, s[12:15], s30 offen offset:3584 sc1
    v_lshlrev_b32 v52, 16, v42
    v_and_b32 v53, s34, v42
    v_fmac_f32 v52, v18, v66
    v_fmac_f32 v53, v18, v67
    s_add_u32 s30, s52, 7168
    buffer_store_dword v52, v4, s[12:15], s30 offen sc1
    buffer_store_dword v53, v4, s[12:15], s30 offen offset:3584 sc1
    v_lshlrev_b32 v54, 16, v43
    v_and_b32 v55, s34, v43
    v_fmac_f32 v54, v18, v74
    v_fmac_f32 v55, v18, v75
    s_add_u32 s30, s52, 35840
    buffer_store_dword v54, v4, s[12:15], s30 offen sc1
    buffer_store_dword v55, v4, s[12:15], s30 offen offset:3584 sc1
    s_waitcnt lgkmcnt(0)
    v_lshlrev_b32 v56, 16, v44
    v_and_b32 v57, s34, v44
    v_fmac_f32 v56, v18, v68
    v_fmac_f32_e64 v57, v18, v69
    s_add_u32 s30, s52, 14336
    buffer_store_dword v56, v4, s[12:15], s30 offen sc1
    buffer_store_dword v57, v4, s[12:15], s30 offen offset:3584 sc1
    v_lshlrev_b32 v58, 16, v45
    v_and_b32 v59, s34, v45
    v_fmac_f32 v58, v18, v76
    v_fmac_f32 v59, v18, v77
    s_add_u32 s30, s52, 43008
    buffer_store_dword v58, v4, s[12:15], s30 offen sc1
    buffer_store_dword v59, v4, s[12:15], s30 offen offset:3584 sc1
    v_lshlrev_b32 v60, 16, v46
    v_and_b32 v61, s34, v46
    v_fmac_f32 v60, v18, v70
    v_fmac_f32 v61, v18, v71
    s_add_u32 s30, s52, 21504
    buffer_store_dword v60, v4, s[12:15], s30 offen sc1
    buffer_store_dword v61, v4, s[12:15], s30 offen offset:3584 sc1
    v_lshlrev_b32 v62, 16, v47
    v_and_b32 v63, s34, v47
    v_fmac_f32 v62, v18, v78
    v_fmac_f32 v63, v18, v79
    s_add_u32 s30, s52, 50176
    buffer_store_dword v62, v4, s[12:15], s30 offen sc1
    buffer_store_dword v63, v4, s[12:15], s30 offen offset:3584 sc1
    s_endpgm
L_a_post:
    v_readfirstlane_b32 s28, v19
    s_cmp_lg_u32 s28, 0
    s_cbranch_scc1 L_a_post1
    s_add_u32 s29, s29, 1
    s_cmp_gt_u32 s29, 131072
    s_cbranch_scc1 L_end
    buffer_load_dword v19, v2, s[16:19], 0 offen sc1
    s_waitcnt vmcnt(0)
    s_branch L_a_post
L_a_post1:
    s_setprio 3
    s_lshl_b32 s48, s2, 7
    s_lshl_b32 s30, s3, 2
    s_add_u32 s48, s48, s30
    s_add_u32 s48, s48, 0x900000
    v_mov_b32 v5, s28
    s_mov_b64 exec, 1
    buffer_store_dword v5, v2, s[8:11], s48 offen sc1
    s_mov_b64 exec, -1
    s_mov_b32 s58, 16
    s_setprio 0
    s_cmp_eq_u32 s59, 0
    s_cbranch_scc1 L_a_pb0
    s_cmp_eq_u32 s59, 1
    s_cbranch_scc1 L_a_pb1
    s_cmp_eq_u32 s59, 2
    s_cbranch_scc1 L_a_pb2
    s_cmp_eq_u32 s59, 3
    s_cbranch_scc1 L_a_pb3
    s_cmp_eq_u32 s59, 4
    s_cbranch_scc1 L_a_pb4
    s_cmp_eq_u32 s59, 5
    s_cbranch_scc1 L_a_pb5
    s_cmp_eq_u32 s59, 6
    s_cbranch_scc1 L_a_pb6
    s_cmp_eq_u32 s59, 7
    s_cbranch_scc1 L_a_pb7
    s_cmp_eq_u32 s59, 8
    s_cbranch_scc1 L_a_pb8
    s_endpgm
    .p2align 6
L_roleB:
    s_load_dwordx16 s[64:79], s[0:1], 56
    s_load_dwordx2 s[86:87], s[0:1], 120
    v_lshrrev_b32 v3, 6, v0
    v_and_b32 v1, 63, v0
    v_mov_b32 v2, 0
    v_readfirstlane_b32 s3, v3
    s_sub_u32 s30, s2, 224
    s_and_b32 s31, s30, 7
    s_lshr_b32 s30, s30, 3
    s_mul_i32 s32, s30, 37
    s_lshr_b32 s32, s32, 8
    s_and_b32 s33, s31, 6
    s_lshl_b32 s36, s33, 1
    s_add_u32 s36, s36, s32
    s_mul_i32 s33, s32, 7
    s_sub_u32 s39, s30, s33
    s_lshl_b32 s33, s32, 1
    s_add_u32 s33, s33, s39
    s_cmp_ge_u32 s33, 7
    s_cselect_b32 s30, 7, 0
    s_sub_u32 s33, s33, s30
    s_lshl_b32 s40, s33, 7
    v_lshrrev_b32 v8, 4, v1
    v_and_b32 v9, 7, v1
    v_xor_b32 v8, v8, v9
    v_lshlrev_b32_e64 v8, 4, v8
    v_bfe_u32 v10, v1, 3, 2
    v_lshrrev_b32_e64 v14, 5, v1
    v_lshl_add_u32 v9, v14, 4, v10
    v_mul_u32_u24 v4, 896, v9
    v_add_u32_e64 v4, v4, v8
    s_lshl_b32 s30, s36, 2
    s_add_u32 s30, s30, s3
    s_mul_i32 s41, s30, 28672
    s_lshl_b32 s45, s3, 12
    s_mov_b32 s22, 1835008
    s_mov_b32 s23, 0x20000
    v_xor_b32 v5, 64, v4
    v_add_u32 v5, 3584, v5
    v_add_u32 v224, 7168, v4
    v_add_u32 v225, 7168, v5
    s_waitcnt lgkmcnt(0)
    s_mov_b32 s20, s64
    s_mov_b32 s21, s65
    s_add_u32 s47, s41, s40
    s_add_u32 m0, s45, 0
    s_nop 0
    buffer_load_dwordx4 v4, s[20:23], s47 offen lds
    s_add_u32 m0, s45, 1024
    s_and_b32 s33, s31, 1
    s_mul_i32 s33, s33, 7
    s_add_u32 s37, s39, s33
    s_lshl_b32 s30, s37, 6
    v_and_b32_e64 v13, 19, v1
    v_bfe_u32 v11, v1, 2, 1
    v_lshl_or_b32 v13, v11, 3, v13
    v_bfe_u32 v11, v1, 3, 1
    v_lshl_or_b32 v13, v11, 2, v13
    v_lshl_add_u32 v13, v13, 1, s30
    v_lshl_add_u32 v9, v14, 3, v10
    v_mul_u32_u24 v46, 896, v9
    buffer_load_dwordx4 v5, s[20:23], s47 offen lds
    s_add_u32 m0, s45, 2048
    v_add_u32 v46, v46, v8
    v_xor_b32 v47, 64, v46
    v_add_u32 v47, 3584, v47
    v_lshrrev_b32_e64 v9, 3, v1
    v_mul_u32_u24 v6, 896, v9
    v_add_u32 v6, v6, v8
    v_xor_b32 v7, 64, v6
    v_add_u32 v7, 7168, v7
    global_load_ushort v10, v13, s[66:67]
    global_load_ushort v11, v13, s[68:69]
    global_load_ushort v12, v13, s[78:79]
    s_lshl_b32 s30, s37, 1
    s_and_b32 s43, s3, 1
    s_add_u32 s30, s30, s43
    buffer_load_dwordx4 v224, s[20:23], s47 offen lds
    s_add_u32 m0, s45, 3072
    s_mul_i32 s42, s30, 14336
    s_lshl_b32 s46, s3, 11
    s_cmp_lt_u32 s3, 2
    s_cselect_b32 s24, s70, s72
    s_cselect_b32 s25, s71, s73
    s_mov_b32 s26, 401408
    s_mov_b32 s27, 0x20000
    s_lshl_b32 s38, s31, 2
    s_add_u32 s38, s38, s32
    v_and_b32 v9, 31, v1
    buffer_load_dwordx4 v225, s[20:23], s47 offen lds
    s_add_u32 s48, s42, s40
    s_add_u32 m0, s46, 16384
    s_nop 0
    buffer_load_dwordx4 v46, s[24:27], s48 offen lds
    s_add_u32 s40, s40, 128
    s_cmp_eq_u32 s40, 896
    s_cselect_b32 s40, 0, s40
    s_add_u32 m0, s46, 17408
    s_nop 0
    buffer_load_dwordx4 v47, s[24:27], s48 offen lds
    s_mul_i32 s35, s39, 57344
    s_mul_i32 s30, s3, 14336
    s_add_u32 s35, s35, s30
    s_lshr_b32 s44, s3, 1
    v_lshrrev_b32 v13, 1, v9
    v_and_b32 v13, 7, v13
    v_xor_b32 v13, v13, v14
    v_lshlrev_b32 v13, 4, v13
    v_lshl_add_u32 v13, v9, 7, v13
    v_xor_b32 v20, 0, v13
    v_xor_b32 v21, 32, v13
    v_xor_b32_e64 v22, 64, v13
    v_xor_b32 v23, 96, v13
    v_add_u32 v16, 16384, v20
    v_add_u32_e64 v20, s45, v20
    v_add_u32 v17, 16384, v21
    v_add_u32_e64 v21, s45, v21
    v_add_u32 v18, 16384, v22
    v_add_u32_e64 v22, s45, v22
    v_add_u32 v19, 16384, v23
    v_add_u32_e64 v23, s45, v23
    s_mov_b32 s12, s80
    s_mov_b32 s13, s81
    s_mov_b32 s14, 0x700000
    s_mov_b32 s15, 0x20000
    s_mov_b32 s16, s82
    s_mov_b32 s17, s83
    s_mov_b32 s18, 0x100
    s_mov_b32 s19, 0x20000
    s_mov_b32 s8, s84
    s_mov_b32 s9, s85
    s_mov_b32 s10, 0x1000000
    s_mov_b32 s11, 0x20000
    s_mov_b32 s29, 0
    s_mov_b32 s34, 0xffff0000
    s_mov_b32 s56, s74
    s_mov_b32 s57, s75
    s_mov_b32 s58, 0x62000
    s_mov_b32 s59, 0x20000
    s_mov_b32 s60, s76
    s_mov_b32 s61, s77
    s_mov_b32 s62, 0x62000
    s_mov_b32 s63, 0x20000
    s_add_u32 s47, s41, s40
    s_add_u32 m0, s45, 24576
    s_nop 0
    buffer_load_dwordx4 v4, s[20:23], s47 offen lds
    s_add_u32 m0, s45, 25600
    s_nop 0
    buffer_load_dwordx4 v5, s[20:23], s47 offen lds
    s_add_u32 m0, s45, 26624
    s_nop 0
    buffer_load_dwordx4 v224, s[20:23], s47 offen lds
    s_add_u32 m0, s45, 27648
    s_nop 0
    buffer_load_dwordx4 v225, s[20:23], s47 offen lds
    s_add_u32 s48, s42, s40
    s_add_u32 m0, s46, 40960
    s_nop 0
    buffer_load_dwordx4 v46, s[24:27], s48 offen lds
    s_add_u32 s40, s40, 128
    s_cmp_eq_u32 s40, 896
    s_cselect_b32 s40, 0, s40
    s_add_u32 m0, s46, 41984
    s_nop 0
    buffer_load_dwordx4 v47, s[24:27], s48 offen lds
    s_waitcnt vmcnt(10)
    s_waitcnt vmcnt(6)
    s_setprio 2
    s_barrier
    s_add_u32 s47, s41, s40
    s_add_u32 m0, s45, 49152
    s_nop 0
    buffer_load_dwordx4 v4, s[20:23], s47 offen lds
    s_add_u32 m0, s45, 50176
    s_nop 0
    s_nop 0
    buffer_load_dwordx4 v5, s[20:23], s47 offen lds
    ds_read_b128 v[128:131], v20 offset:0
    ds_read_b128 v[132:135], v16 offset:0
    ds_read_b128 v[136:139], v16 offset:4096
    s_add_u32 m0, s45, 51200
    s_nop 0
    buffer_load_dwordx4 v224, s[20:23], s47 offen lds
    s_add_u32 m0, s45, 52224
    s_nop 0
    buffer_load_dwordx4 v225, s[20:23], s47 offen lds
    ds_read_b128 v[140:143], v21 offset:0
    ds_read_b128 v[144:147], v17 offset:0
    ds_read_b128 v[148:151], v17 offset:4096
    s_add_u32 s48, s42, s40
    s_add_u32 m0, s46, 65536
    s_nop 0
    buffer_load_dwordx4 v46, s[24:27], s48 offen lds
    s_add_u32 s40, s40, 128
    s_cmp_eq_u32 s40, 896
    s_cselect_b32 s40, 0, s40
    s_add_u32 m0, s46, 66560
    s_nop 0
    buffer_load_dwordx4 v47, s[24:27], s48 offen lds
    ds_read_b128 v[152:155], v22 offset:0
    ds_read_b128 v[156:159], v18 offset:0
    ds_read_b128 v[160:163], v18 offset:4096
    ds_read_b128 v[164:167], v23 offset:0
    ds_read_b128 v[168:171], v19 offset:0
    ds_read_b128 v[172:175], v19 offset:4096
    s_waitcnt lgkmcnt(9)
    v_mfma_f32_32x32x16_bf16 v[96:111], v[128:131], v[132:135], 0
    s_lshl_b32 s30, s36, 2
    s_add_u32 s30, s30, s3
    s_mul_i32 s67, s30, 57344
    s_lshl_b32 s30, s37, 11
    s_add_u32 s67, s67, s30
    v_mfma_f32_32x32x16_bf16 v[112:127], v[128:131], v[136:139], 0
    s_add_u32 s67, s67, 0x410000
    s_add_u32 s68, s67, 28672
    v_lshlrev_b32_e64 v0, 4, v1
    s_lshl_b32 s64, s37, 13
    s_add_u32 s64, s64, 0x800000
    s_waitcnt vmcnt(6)
    s_waitcnt lgkmcnt(0)
    s_barrier
    v_mfma_f32_32x32x16_bf16 v[96:111], v[140:143], v[144:147], v[96:111]
    s_add_u32 s47, s41, s40
    s_add_u32 m0, s45, 0
    ds_read_b128 v[176:179], v20 offset:24576
    buffer_load_dwordx4 v4, s[20:23], s47 offen lds
    ds_read_b128 v[180:183], v16 offset:24576
    s_lshl_b32 s30, s36, 9
    s_add_u32 s66, s64, s30
    v_mfma_f32_32x32x16_bf16 v[112:127], v[140:143], v[148:151], v[112:127]
    s_add_u32 m0, s45, 1024
    ds_read_b128 v[184:187], v16 offset:28672
    buffer_load_dwordx4 v5, s[20:23], s47 offen lds
    ds_read_b128 v[188:191], v21 offset:24576
    s_lshl_b32 s73, s36, 11
    s_lshl_b32 s30, s37, 7
    v_mfma_f32_32x32x16_bf16 v[96:111], v[152:155], v[156:159], v[96:111]
    s_add_u32 m0, s45, 2048
    ds_read_b128 v[192:195], v17 offset:24576
    buffer_load_dwordx4 v224, s[20:23], s47 offen lds
    ds_read_b128 v[196:199], v17 offset:28672
    s_add_u32 s73, s73, s30
    s_add_u32 s73, s73, 0x920000
    v_mfma_f32_32x32x16_bf16 v[112:127], v[152:155], v[160:163], v[112:127]
    s_add_u32 m0, s45, 3072
    ds_read_b128 v[200:203], v22 offset:24576
    buffer_load_dwordx4 v225, s[20:23], s47 offen lds
    ds_read_b128 v[204:207], v18 offset:24576
    v_lshlrev_b32_e64 v12, 16, v12
    v_mul_f32 v12, 0x3fb8aa3b, v12
    v_mfma_f32_32x32x16_bf16 v[96:111], v[164:167], v[168:171], v[96:111]
    s_add_u32 s48, s42, s40
    s_add_u32 m0, s46, 16384
    ds_read_b128 v[208:211], v18 offset:28672
    buffer_load_dwordx4 v46, s[24:27], s48 offen lds
    ds_read_b128 v[212:215], v23 offset:24576
    v_exp_f32 v12, v12
    v_lshlrev_b32_e64 v10, 16, v10
    v_mfma_f32_32x32x16_bf16 v[112:127], v[164:167], v[172:175], v[112:127]
    s_add_u32 s40, s40, 128
    s_cmp_eq_u32 s40, 896
    s_cselect_b32 s40, 0, s40
    s_add_u32 m0, s46, 17408
    ds_read_b128 v[216:219], v19 offset:24576
    buffer_load_dwordx4 v47, s[24:27], s48 offen lds
    ds_read_b128 v[220:223], v19 offset:28672
    v_lshlrev_b32 v11, 16, v11
    v_cvt_pk_bf16_f32 v12, v12, v12
    s_waitcnt lgkmcnt(9)
    v_mfma_f32_32x32x16_bf16 v[96:111], v[176:179], v[180:183], v[96:111]
    v_lshlrev_b32 v12, 16, v12
    v_mul_f32 v38, v10, v12
    v_mul_f32 v39, v11, v12
    v_mul_f32 v38, 0x3fb8aa3b, v38
    v_mul_f32_e64 v39, 0x3e22f983, v39
    v_mfma_f32_32x32x16_bf16 v[112:127], v[176:179], v[184:187], v[112:127]
    v_mov_b32 v40, v38
    v_mov_b32 v41, v39
    v_exp_f32 v40, v40
    v_fract_f32 v41, v41
    v_cos_f32 v24, v41
    s_waitcnt vmcnt(6)
    s_waitcnt lgkmcnt(0)
    s_barrier
    v_mfma_f32_32x32x16_bf16 v[96:111], v[188:191], v[192:195], v[96:111]
    s_add_u32 s47, s41, s40
    s_add_u32 m0, s45, 24576
    ds_read_b128 v[128:131], v20 offset:49152
    buffer_load_dwordx4 v4, s[20:23], s47 offen lds
    ds_read_b128 v[132:135], v16 offset:49152
    v_sin_f32_e64 v25, v41
    s_nop 0
    v_mfma_f32_32x32x16_bf16 v[112:127], v[188:191], v[196:199], v[112:127]
    s_add_u32 m0, s45, 25600
    ds_read_b128 v[136:139], v16 offset:53248
    buffer_load_dwordx4 v5, s[20:23], s47 offen lds
    ds_read_b128 v[140:143], v21 offset:49152
    v_mul_f32 v24, v24, v40
    v_mul_f32 v25, v25, v40
    v_mfma_f32_32x32x16_bf16 v[96:111], v[200:203], v[204:207], v[96:111]
    s_add_u32 m0, s45, 26624
    ds_read_b128 v[144:147], v17 offset:49152
    buffer_load_dwordx4 v224, s[20:23], s47 offen lds
    ds_read_b128 v[148:151], v17 offset:53248
    v_mul_f32 v40, v10, v10
    v_fmac_f32 v40, v11, v11
    v_mfma_f32_32x32x16_bf16 v[112:127], v[200:203], v[208:211], v[112:127]
    s_add_u32 m0, s45, 27648
    ds_read_b128 v[152:155], v22 offset:49152
    buffer_load_dwordx4 v225, s[20:23], s47 offen lds
    ds_read_b128 v[156:159], v18 offset:49152
    v_rcp_f32 v40, v40
    v_add_f32 v41, -1.0, v24
    v_mfma_f32_32x32x16_bf16 v[96:111], v[212:215], v[216:219], v[96:111]
    s_add_u32 s48, s42, s40
    s_add_u32 m0, s46, 40960
    ds_read_b128 v[160:163], v18 offset:53248
    buffer_load_dwordx4 v46, s[24:27], s48 offen lds
    ds_read_b128 v[164:167], v23 offset:49152
    v_mul_f32 v26, v41, v10
    v_fmac_f32_e64 v26, v25, v11
    v_mfma_f32_32x32x16_bf16 v[112:127], v[212:215], v[220:223], v[112:127]
    s_add_u32 s40, s40, 128
    s_cmp_eq_u32 s40, 896
    s_cselect_b32 s40, 0, s40
    s_add_u32 m0, s46, 41984
    ds_read_b128 v[168:171], v19 offset:49152
    buffer_load_dwordx4 v47, s[24:27], s48 offen lds
    ds_read_b128 v[172:175], v19 offset:53248
    v_mul_f32 v27, v25, v10
    v_fma_f32 v27, -v41, v11, v27
    s_waitcnt lgkmcnt(9)
    v_mfma_f32_32x32x16_bf16 v[96:111], v[128:131], v[132:135], v[96:111]
    v_add_f32 v40, v40, v40
    v_mul_f32 v26, v26, v40
    v_mul_f32 v27, v27, v40
    v_lshl_add_u32 v15, s3, 1, v14
    v_lshlrev_b32_e64 v42, 4, v15
    v_mfma_f32_32x32x16_bf16 v[112:127], v[128:131], v[136:139], v[112:127]
    v_cvt_f32_u32 v42, v42
    v_mul_f32 v40, v42, v38
    v_mul_f32 v41, v42, v39
    v_exp_f32 v40, v40
    v_fract_f32 v41, v41
    s_waitcnt vmcnt(6)
    s_waitcnt lgkmcnt(0)
    s_barrier
    buffer_load_dword v44, v2, s[16:19], 0 offen sc1
    v_mfma_f32_32x32x16_bf16 v[96:111], v[140:143], v[144:147], v[96:111]
    s_add_u32 s47, s41, s40
    s_add_u32 m0, s45, 49152
    ds_read_b128 v[176:179], v20 offset:0
    buffer_load_dwordx4 v4, s[20:23], s47 offen lds
    ds_read_b128 v[180:183], v16 offset:0
    v_cos_f32 v30, v41
    v_sin_f32_e64 v31, v41
    v_mfma_f32_32x32x16_bf16 v[112:127], v[140:143], v[148:151], v[112:127]
    s_add_u32 m0, s45, 50176
    ds_read_b128 v[184:187], v16 offset:4096
    buffer_load_dwordx4 v5, s[20:23], s47 offen lds
    ds_read_b128 v[188:191], v21 offset:0
    s_nop 0
    v_mul_f32 v30, v30, v40
    v_mfma_f32_32x32x16_bf16 v[96:111], v[152:155], v[156:159], v[96:111]
    s_add_u32 m0, s45, 51200
    ds_read_b128 v[192:195], v17 offset:0
    buffer_load_dwordx4 v224, s[20:23], s47 offen lds
    ds_read_b128 v[196:199], v17 offset:4096
    v_mul_f32_e64 v31, v31, v40
    v_sub_f32 v42, 0x42e00000, v42
    v_mfma_f32_32x32x16_bf16 v[112:127], v[152:155], v[160:163], v[112:127]
    s_add_u32 m0, s45, 52224
    ds_read_b128 v[200:203], v22 offset:0
    buffer_load_dwordx4 v225, s[20:23], s47 offen lds
    ds_read_b128 v[204:207], v18 offset:0
    v_mul_f32 v40, v42, v38
    v_mul_f32 v41, v42, v39
    v_mfma_f32_32x32x16_bf16 v[96:111], v[164:167], v[168:171], v[96:111]
    s_add_u32 s48, s42, s40
    s_add_u32 m0, s46, 65536
    ds_read_b128 v[208:211], v18 offset:4096
    buffer_load_dwordx4 v46, s[24:27], s48 offen lds
    ds_read_b128 v[212:215], v23 offset:0
    v_exp_f32 v40, v40
    v_fract_f32_e64 v41, v41
    v_mfma_f32_32x32x16_bf16 v[112:127], v[164:167], v[172:175], v[112:127]
    s_add_u32 s40, s40, 128
    s_cmp_eq_u32 s40, 896
    s_cselect_b32 s40, 0, s40
    s_add_u32 m0, s46, 66560
    ds_read_b128 v[216:219], v19 offset:0
    buffer_load_dwordx4 v47, s[24:27], s48 offen lds
    ds_read_b128 v[220:223], v19 offset:4096
    v_cos_f32 v32, v41
    v_sin_f32 v33, v41
    s_waitcnt lgkmcnt(9)
    v_mfma_f32_32x32x16_bf16 v[96:111], v[176:179], v[180:183], v[96:111]
    s_nop 0
    v_mul_f32 v32, v32, v40
    v_mul_f32 v33, v33, v40
    v_lshlrev_b32 v8, 4, v9
    v_add_u32 v13, 73728, v8
    v_mfma_f32_32x32x16_bf16 v[112:127], v[176:179], v[184:187], v[112:127]
    v_lshl_add_u32 v12, v15, 9, v13
    v_lshl_add_u32 v10, v15, 9, v8
    s_add_u32 s65, s64, 4096
    s_lshl_b32 s32, s38, 1
    s_add_u32 s32, s32, s43
    s_waitcnt vmcnt(7)
    s_waitcnt lgkmcnt(0)
    s_barrier
    v_mfma_f32_32x32x16_bf16 v[96:111], v[188:191], v[192:195], v[96:111]
    s_add_u32 s47, s41, s40
    s_add_u32 m0, s45, 0
    s_nop 0
    ds_read_b128 v[128:131], v20 offset:24576
    buffer_load_dwordx4 v4, s[20:23], s47 offen lds
    ds_read_b128 v[132:135], v16 offset:24576
    s_mul_i32 s76, s32, 57344
    s_mul_i32 s33, s44, 28672
    v_mfma_f32_32x32x16_bf16 v[112:127], v[188:191], v[196:199], v[112:127]
    s_add_u32 m0, s45, 1024
    ds_read_b128 v[136:139], v16 offset:28672
    buffer_load_dwordx4 v5, s[20:23], s47 offen lds
    ds_read_b128 v[140:143], v21 offset:24576
    s_add_u32 s76, s76, s33
    s_nop 0
    s_add_u32 s76, s76, 0x410000
    v_mfma_f32_32x32x16_bf16 v[96:111], v[200:203], v[204:207], v[96:111]
    s_add_u32 m0, s45, 2048
    ds_read_b128 v[144:147], v17 offset:24576
    buffer_load_dwordx4 v224, s[20:23], s47 offen lds
    ds_read_b128 v[148:151], v17 offset:28672
    s_lshl_b32 s72, s39, 1
    s_add_u32 s72, s72, s44
    v_mfma_f32_32x32x16_bf16 v[112:127], v[200:203], v[208:211], v[112:127]
    s_add_u32 m0, s45, 3072
    ds_read_b128 v[152:155], v22 offset:24576
    buffer_load_dwordx4 v225, s[20:23], s47 offen lds
    ds_read_b128 v[156:159], v18 offset:24576
    s_lshl_b32 s72, s72, 6
    s_mul_i32 s71, s32, 114688
    v_mfma_f32_32x32x16_bf16 v[96:111], v[212:215], v[216:219], v[96:111]
    s_add_u32 s48, s42, s40
    s_add_u32 m0, s46, 16384
    ds_read_b128 v[160:163], v18 offset:28672
    buffer_load_dwordx4 v46, s[24:27], s48 offen lds
    ds_read_b128 v[164:167], v23 offset:24576
    s_lshl_b32 s32, s72, 1
    s_add_u32 s71, s71, s32
    v_mfma_f32_32x32x16_bf16 v[112:127], v[212:215], v[220:223], v[112:127]
    s_add_u32 s40, s40, 128
    s_cmp_eq_u32 s40, 896
    s_cselect_b32 s40, 0, s40
    s_nop 0
    s_add_u32 m0, s46, 17408
    ds_read_b128 v[168:171], v19 offset:24576
    buffer_load_dwordx4 v47, s[24:27], s48 offen lds
    ds_read_b128 v[172:175], v19 offset:28672
    s_add_u32 s71, s71, 1792
    s_lshl_b32 s32, s38, 2
    s_waitcnt lgkmcnt(9)
    v_mfma_f32_32x32x16_bf16 v[96:111], v[128:131], v[132:135], v[96:111]
    s_add_u32 s32, s32, s3
    s_mul_i32 s70, s32, 14336
    s_lshl_b32 s32, s39, 7
    s_add_u32 s70, s70, s32
    s_lshr_b32 s74, s38, 1
    v_mfma_f32_32x32x16_bf16 v[112:127], v[128:131], v[136:139], v[112:127]
    s_lshl_b32 s74, s74, 11
    s_add_u32 s74, s74, 0x920000
    s_mov_b32 s77, 0x07060302
    v_mul_f32 v40, 0x41800000, v38
    v_mul_f32 v41, 0x41800000, v39
    s_waitcnt vmcnt(6)
    s_waitcnt lgkmcnt(0)
    s_barrier
L_b_nchk:
    v_readfirstlane_b32 s28, v44
    s_cmp_lg_u32 s28, 0
    s_cbranch_scc1 L_b_nok
    s_add_u32 s29, s29, 1
    s_cmp_gt_u32 s29, 131072
    s_cbranch_scc1 L_end
    buffer_load_dword v44, v2, s[16:19], 0 offen sc1
    s_waitcnt vmcnt(0)
    s_branch L_b_nchk
L_b_nok:
    v_mfma_f32_32x32x16_bf16 v[96:111], v[140:143], v[144:147], v[96:111]
    s_add_u32 s49, s35, 0
    s_add_u32 m0, s46, 24576
    ds_read_b128 v[176:179], v20 offset:49152
    buffer_load_dwordx4 v6, s[56:59], s49 offen lds
    ds_read_b128 v[180:183], v16 offset:49152
    v_mfma_f32_32x32x16_bf16 v[112:127], v[140:143], v[148:151], v[112:127]
    ds_read_b128 v[184:187], v16 offset:53248
    ds_read_b128 v[188:191], v21 offset:49152
    v_mfma_f32_32x32x16_bf16 v[96:111], v[152:155], v[156:159], v[96:111]
    s_add_u32 m0, s46, 25600
    ds_read_b128 v[192:195], v17 offset:49152
    buffer_load_dwordx4 v7, s[56:59], s49 offen lds
    ds_read_b128 v[196:199], v17 offset:53248
    v_mfma_f32_32x32x16_bf16 v[112:127], v[152:155], v[160:163], v[112:127]
    ds_read_b128 v[200:203], v22 offset:49152
    ds_read_b128 v[204:207], v18 offset:49152
    v_mfma_f32_32x32x16_bf16 v[96:111], v[164:167], v[168:171], v[96:111]
    s_add_u32 s49, s35, 128
    s_add_u32 m0, s46, 32768
    ds_read_b128 v[208:211], v18 offset:53248
    buffer_load_dwordx4 v6, s[56:59], s49 offen lds
    ds_read_b128 v[212:215], v23 offset:49152
    v_mfma_f32_32x32x16_bf16 v[112:127], v[164:167], v[172:175], v[112:127]
    s_add_u32 m0, s46, 33792
    ds_read_b128 v[216:219], v19 offset:49152
    buffer_load_dwordx4 v7, s[56:59], s49 offen lds
    ds_read_b128 v[220:223], v19 offset:53248
    s_waitcnt lgkmcnt(9)
    v_mfma_f32_32x32x16_bf16 v[96:111], v[176:179], v[180:183], v[96:111]
    v_exp_f32 v40, v40
    v_fract_f32 v41, v41
    v_cos_f32 v28, v41
    v_sin_f32 v29, v41
    s_nop 0
    v_mfma_f32_32x32x16_bf16 v[112:127], v[176:179], v[184:187], v[112:127]
    v_mul_f32 v28, v28, v40
    v_mul_f32 v29, v29, v40
    v_sub_u32_e64 v42, s36, v15
    v_cmp_le_i32 s[52:53], 1, v42
    v_cmp_le_i32 s[54:55], 9, v42
    s_waitcnt vmcnt(4)
    s_waitcnt lgkmcnt(0)
    s_barrier
    s_nop 0
    v_mfma_f32_32x32x16_bf16 v[96:111], v[188:191], v[192:195], v[96:111]
    s_add_u32 s49, s35, 256
    s_add_u32 m0, s46, 40960
    ds_read_b128 v[128:131], v20 offset:0
    buffer_load_dwordx4 v6, s[56:59], s49 offen lds
    ds_read_b128 v[132:135], v16 offset:0
    v_mfma_f32_32x32x16_bf16 v[112:127], v[188:191], v[196:199], v[112:127]
    ds_read_b128 v[136:139], v16 offset:4096
    ds_read_b128 v[140:143], v21 offset:0
    v_mfma_f32_32x32x16_bf16 v[96:111], v[200:203], v[204:207], v[96:111]
    s_add_u32 m0, s46, 41984
    ds_read_b128 v[144:147], v17 offset:0
    buffer_load_dwordx4 v7, s[56:59], s49 offen lds
    ds_read_b128 v[148:151], v17 offset:4096
    v_mfma_f32_32x32x16_bf16 v[112:127], v[200:203], v[208:211], v[112:127]
    ds_read_b128 v[152:155], v22 offset:0
    ds_read_b128 v[156:159], v18 offset:0
    v_mfma_f32_32x32x16_bf16 v[96:111], v[212:215], v[216:219], v[96:111]
    s_add_u32 s49, s35, 0
    s_nop 0
    s_add_u32 m0, s46, 49152
    ds_read_b128 v[160:163], v18 offset:4096
    buffer_load_dwordx4 v6, s[60:63], s49 offen lds
    ds_read_b128 v[164:167], v23 offset:0
    v_mfma_f32_32x32x16_bf16 v[112:127], v[212:215], v[220:223], v[112:127]
    s_add_u32 m0, s46, 50176
    ds_read_b128 v[168:171], v19 offset:0
    buffer_load_dwordx4 v7, s[60:63], s49 offen lds
    ds_read_b128 v[172:175], v19 offset:4096
    s_waitcnt lgkmcnt(9)
    v_mfma_f32_32x32x16_bf16 v[96:111], v[128:131], v[132:135], v[96:111]
    v_add_u32 v43, -9, v42
    v_add_u32 v42, -1, v42
    v_max_i32 v42, 0, v42
    v_max_i32 v43, 0, v43
    v_lshlrev_b32 v42, 7, v42
    v_mfma_f32_32x32x16_bf16 v[112:127], v[128:131], v[136:139], v[112:127]
    v_lshlrev_b32 v43, 7, v43
    v_cvt_f32_u32 v42, v42
    v_cvt_f32_u32 v43, v43
    v_mul_f32 v40, v42, v38
    v_mul_f32 v41, v42, v39
    s_waitcnt lgkmcnt(6)
    v_mfma_f32_32x32x16_bf16 v[96:111], v[140:143], v[144:147], v[96:111]
    s_add_u32 s49, s35, 128
    s_add_u32 m0, s46, 57344
    s_nop 0
    buffer_load_dwordx4 v6, s[60:63], s49 offen lds
    v_mfma_f32_32x32x16_bf16 v[112:127], v[140:143], v[148:151], v[112:127]
    s_waitcnt lgkmcnt(3)
    v_mfma_f32_32x32x16_bf16 v[96:111], v[152:155], v[156:159], v[96:111]
    s_add_u32 m0, s46, 58368
    s_nop 0
    buffer_load_dwordx4 v7, s[60:63], s49 offen lds
    v_mfma_f32_32x32x16_bf16 v[112:127], v[152:155], v[160:163], v[112:127]
    s_waitcnt lgkmcnt(0)
    v_mfma_f32_32x32x16_bf16 v[96:111], v[164:167], v[168:171], v[96:111]
    s_add_u32 s49, s35, 256
    s_add_u32 m0, s46, 65536
    s_nop 0
    buffer_load_dwordx4 v6, s[60:63], s49 offen lds
    v_mfma_f32_32x32x16_bf16 v[112:127], v[164:167], v[172:175], v[112:127]
    s_add_u32 m0, s46, 66560
    s_nop 0
    buffer_load_dwordx4 v7, s[60:63], s49 offen lds
    s_setprio 2
    s_nop 13
    v_fma_f32 v44, -v25, v112, v97
    v_fma_f32 v45, v25, v96, v113
    v_fmac_f32 v44, v24, v96
    v_fmac_f32 v45, v24, v112
    v_fma_f32 v46, -v25, v45, v98
    v_fma_f32 v47, v25, v44, v114
    v_fmac_f32 v46, v24, v44
    v_fmac_f32 v47, v24, v45
    v_fma_f32 v44, -v25, v47, v99
    v_fma_f32 v45, v25, v46, v115
    v_fmac_f32 v44, v24, v46
    v_fmac_f32 v45, v24, v47
    v_fma_f32 v46, -v25, v45, v100
    v_fma_f32 v47, v25, v44, v116
    v_fmac_f32 v46, v24, v44
    v_fmac_f32 v47, v24, v45
    v_fma_f32 v44, -v25, v47, v101
    v_fma_f32 v45, v25, v46, v117
    v_fmac_f32 v44, v24, v46
    v_fmac_f32 v45, v24, v47
    v_fma_f32 v46, -v25, v45, v102
    v_fma_f32 v47, v25, v44, v118
    v_fmac_f32 v46, v24, v44
    v_fmac_f32 v47, v24, v45
    v_fma_f32 v44, -v25, v47, v103
    v_fma_f32 v45, v25, v46, v119
    v_fmac_f32 v44, v24, v46
    v_fmac_f32 v45, v24, v47
    v_fma_f32 v46, -v25, v45, v104
    v_fma_f32 v47, v25, v44, v120
    v_fmac_f32 v46, v24, v44
    v_fmac_f32 v47, v24, v45
    v_fma_f32 v44, -v25, v47, v105
    v_fma_f32 v45, v25, v46, v121
    v_fmac_f32 v44, v24, v46
    v_fmac_f32 v45, v24, v47
    v_fma_f32 v46, -v25, v45, v106
    v_fma_f32 v47, v25, v44, v122
    v_fmac_f32 v46, v24, v44
    v_fmac_f32 v47, v24, v45
    v_fma_f32 v44, -v25, v47, v107
    v_fma_f32 v45, v25, v46, v123
    v_fmac_f32 v44, v24, v46
    v_fmac_f32 v45, v24, v47
    v_fma_f32 v46, -v25, v45, v108
    v_fma_f32 v47, v25, v44, v124
    v_fmac_f32 v46, v24, v44
    v_fmac_f32 v47, v24, v45
    v_fma_f32 v44, -v25, v47, v109
    v_fma_f32 v45, v25, v46, v125
    v_fmac_f32 v44, v24, v46
    v_fmac_f32 v45, v24, v47
    v_fma_f32 v46, -v25, v45, v110
    v_fma_f32 v47, v25, v44, v126
    v_fmac_f32 v46, v24, v44
    v_fmac_f32 v47, v24, v45
    v_fma_f32 v44, -v25, v47, v111
    v_fma_f32 v45, v25, v46, v127
    v_fmac_f32 v44, v24, v46
    v_fmac_f32 v45, v24, v47
    v_mul_f32 v63, v45, v33
    v_mul_f32 v47, v45, v32
    v_fma_f32 v46, v44, v32, -v63
    v_fmac_f32_e64 v47, v44, v33
    ds_write_b128 v12, v[44:47]
    s_waitcnt lgkmcnt(0)
    s_barrier
    ds_read_b128 v[128:131], v13 offset:0
    ds_read_b128 v[132:135], v13 offset:512
    ds_read_b128 v[136:139], v13 offset:1024
    ds_read_b128 v[140:143], v13 offset:1536
    ds_read_b128 v[144:147], v13 offset:2048
    ds_read_b128 v[148:151], v13 offset:2560
    ds_read_b128 v[152:155], v13 offset:3072
    ds_read_b128 v[156:159], v13 offset:3584
    s_cmp_lg_u32 s3, 0
    s_cbranch_scc1 L_b_nopub
    v_mov_b32 v46, s28
    v_mov_b32 v47, s28
    s_waitcnt lgkmcnt(6)
    v_add_f32 v44, v130, v134
    v_add_f32 v45, v131, v135
    s_waitcnt lgkmcnt(4)
    v_add_f32 v44, v44, v138
    v_add_f32 v45, v45, v139
    v_add_f32 v44, v44, v142
    v_add_f32 v45, v45, v143
    s_waitcnt lgkmcnt(2)
    v_add_f32 v44, v44, v146
    v_add_f32 v45, v45, v147
    v_add_f32 v44, v44, v150
    v_add_f32 v45, v45, v151
    s_waitcnt lgkmcnt(0)
    v_add_f32 v44, v44, v154
    v_add_f32 v45, v45, v155
    v_add_f32 v44, v44, v158
    v_add_f32_e64 v45, v45, v159
    s_mov_b32 exec_hi, 0
    buffer_store_dwordx4 v[44:47], v8, s[8:11], s66 offen sc1
    s_mov_b64 exec, -1
L_b_nopub:
    s_setprio 2
    s_and_b32 s30, s38, 3
    s_lshl_b32 s30, s30, 2
    s_add_u32 s30, s30, s3
    s_mul_i32 s30, s30, 3584
    s_mul_i32 s31, s39, 57344
    s_add_u32 s31, s31, s30
    v_mul_u32_u24 v4, 896, v1
    s_mov_b64 exec, 15
    s_nop 0
    s_add_u32 s30, s31, 768
    buffer_load_dword v5, v4, s[56:59], s30 offen
    s_add_u32 s30, s31, 384
    buffer_load_dword v5, v4, s[60:63], s30 offen
    s_add_u32 s30, s31, 512
    buffer_load_dword v5, v4, s[60:63], s30 offen
    s_add_u32 s30, s31, 640
    buffer_load_dword v5, v4, s[60:63], s30 offen
    s_add_u32 s30, s31, 768
    buffer_load_dword v5, v4, s[60:63], s30 offen
    s_mov_b64 exec, -1
    s_add_u32 s49, s35, 384
    s_add_u32 m0, s46, 0
    s_nop 0
    buffer_load_dwordx4 v6, s[56:59], s49 offen lds
    s_add_u32 m0, s46, 1024
    s_nop 0
    buffer_load_dwordx4 v7, s[56:59], s49 offen lds
    s_add_u32 s49, s35, 512
    s_add_u32 m0, s46, 8192
    s_nop 0
    buffer_load_dwordx4 v6, s[56:59], s49 offen lds
    s_add_u32 m0, s46, 9216
    s_nop 0
    buffer_load_dwordx4 v7, s[56:59], s49 offen lds
    s_add_u32 s49, s35, 640
    s_add_u32 m0, s46, 16384
    s_nop 0
    buffer_load_dwordx4 v6, s[56:59], s49 offen lds
    s_add_u32 m0, s46, 17408
    s_nop 0
    buffer_load_dwordx4 v7, s[56:59], s49 offen lds
    v_exp_f32 v40, v40
    v_fract_f32 v41, v41
    v_cos_f32 v34, v41
    v_sin_f32 v35, v41
    s_nop 0
    v_mul_f32 v34, v34, v40
    v_mul_f32 v35, v35, v40
    v_mul_f32 v40, v43, v38
    v_mul_f32 v41, v43, v39
    v_exp_f32 v40, v40
    v_fract_f32 v41, v41
    v_cos_f32 v36, v41
    v_sin_f32 v37, v41
    s_nop 0
    v_mul_f32 v36, v36, v40
    v_mul_f32 v37, v37, v40
    v_lshlrev_b32_e64 v60, 3, v9
    v_add_u32 v60, 77824, v60
    v_lshl_add_u32 v61, v15, 8, v60
    v_min_u32 v62, 13, v1
    v_lshlrev_b32 v62, 7, v62
    v_lshlrev_b32 v40, 4, v14
    v_sub_u32 v40, v9, v40
    v_mov_b32 v41, 0x3f80
    v_mov_b32_e64 v42, 0x3f800000
    v_cmp_eq_u32 s[88:89], 0, v40
    v_cmp_eq_u32 s[50:51], 2, v40
    v_cmp_eq_u32 s[78:79], 1, v40
    v_cndmask_b32 v48, 0, v41, s[88:89]
    v_cmp_eq_u32 s[88:89], 3, v40
    v_cndmask_b32 v49, 0, v41, s[50:51]
    v_cndmask_b32 v48, v48, v42, s[78:79]
    v_cndmask_b32 v49, v49, v42, s[88:89]
    v_cmp_eq_u32 s[88:89], 4, v40
    v_cmp_eq_u32 s[50:51], 6, v40
    v_cmp_eq_u32 s[78:79], 5, v40
    v_cndmask_b32 v50, 0, v41, s[88:89]
    v_cmp_eq_u32 s[88:89], 7, v40
    v_cndmask_b32 v51, 0, v41, s[50:51]
    v_cndmask_b32 v50, v50, v42, s[78:79]
    v_cndmask_b32 v51, v51, v42, s[88:89]
    v_cmp_eq_u32 s[88:89], 8, v40
    v_cmp_eq_u32 s[50:51], 10, v40
    v_cmp_eq_u32 s[78:79], 9, v40
    v_cndmask_b32 v52, 0, v41, s[88:89]
    v_cmp_eq_u32 s[88:89], 11, v40
    v_cndmask_b32 v53, 0, v41, s[50:51]
    v_cndmask_b32 v52, v52, v42, s[78:79]
    v_cndmask_b32 v53, v53, v42, s[88:89]
    v_cmp_eq_u32 s[88:89], 12, v40
    v_cmp_eq_u32 s[50:51], 14, v40
    v_cmp_eq_u32 s[78:79], 13, v40
    v_cndmask_b32 v54, 0, v41, s[88:89]
    v_cmp_eq_u32 s[88:89], 15, v40
    v_cndmask_b32 v55, 0, v41, s[50:51]
    v_cndmask_b32 v54, v54, v42, s[78:79]
    v_cndmask_b32 v55, v55, v42, s[88:89]
    v_mov_b32 v38, 0
    v_mov_b32 v39, 0
    s_waitcnt lgkmcnt(0)
    v_cmp_eq_u32 vcc, 1, v15
    v_fma_f32 v132, -v29, v129, v132
    v_fmac_f32 v133, v29, v128
    v_fmac_f32 v132, v28, v128
    v_fmac_f32 v133, v28, v129
    v_cndmask_b32 v38, v38, v128, vcc
    v_cndmask_b32 v39, v39, v129, vcc
    v_cmp_eq_u32 vcc, 2, v15
    v_fma_f32 v136, -v29, v133, v136
    v_fmac_f32 v137, v29, v132
    v_fmac_f32 v136, v28, v132
    v_fmac_f32 v137, v28, v133
    v_cndmask_b32 v38, v38, v132, vcc
    v_cndmask_b32 v39, v39, v133, vcc
    v_cmp_eq_u32 vcc, 3, v15
    v_fma_f32 v140, -v29, v137, v140
    v_fmac_f32 v141, v29, v136
    v_fmac_f32 v140, v28, v136
    v_fmac_f32 v141, v28, v137
    v_cndmask_b32 v38, v38, v136, vcc
    v_cndmask_b32 v39, v39, v137, vcc
    v_cmp_eq_u32 vcc, 4, v15
    v_fma_f32 v144, -v29, v141, v144
    v_fmac_f32 v145, v29, v140
    v_fmac_f32 v144, v28, v140
    v_fmac_f32 v145, v28, v141
    v_cndmask_b32 v38, v38, v140, vcc
    v_cndmask_b32 v39, v39, v141, vcc
    v_cmp_eq_u32 vcc, 5, v15
    v_fma_f32 v148, -v29, v145, v148
    v_fmac_f32 v149, v29, v144
    v_fmac_f32 v148, v28, v144
    v_fmac_f32 v149, v28, v145
    v_cndmask_b32 v38, v38, v144, vcc
    v_cndmask_b32 v39, v39, v145, vcc
    v_cmp_eq_u32 vcc, 6, v15
    v_fma_f32 v152, -v29, v149, v152
    v_fmac_f32 v153, v29, v148
    v_fmac_f32 v152, v28, v148
    v_fmac_f32 v153, v28, v149
    v_cndmask_b32 v38, v38, v148, vcc
    v_cndmask_b32 v39, v39, v149, vcc
    v_cmp_eq_u32 vcc, 7, v15
    s_nop 1
    v_cndmask_b32 v38, v38, v152, vcc
    v_cndmask_b32 v39, v39, v153, vcc
    v_sub_f32 v72, 0, v26
    v_sub_f32 v73, 0, v27
    v_sub_f32 v32, 0, v25
    v_mul_f32 v63, v26, v96
    v_fmac_f32 v63, v73, v112
    v_mul_f32 v112, v72, v112
    v_fmac_f32 v112, v73, v96
    v_mul_f32 v96, v26, v97
    v_fmac_f32 v96, v73, v113
    v_mul_f32 v113, v72, v113
    v_fmac_f32 v113, v73, v97
    v_mul_f32 v97, v26, v98
    v_fmac_f32 v97, v73, v114
    v_mul_f32 v114, v72, v114
    v_fmac_f32 v114, v73, v98
    v_mul_f32 v98, v26, v99
    v_fmac_f32 v98, v73, v115
    v_mul_f32 v115, v72, v115
    v_fmac_f32 v115, v73, v99
    v_mul_f32 v99, v26, v100
    v_fmac_f32 v99, v73, v116
    v_mul_f32 v116, v72, v116
    v_fmac_f32 v116, v73, v100
    v_mul_f32 v100, v26, v101
    v_fmac_f32 v100, v73, v117
    v_mul_f32 v117, v72, v117
    v_fmac_f32 v117, v73, v101
    v_mul_f32 v101, v26, v102
    v_fmac_f32 v101, v73, v118
    v_mul_f32 v118, v72, v118
    v_fmac_f32 v118, v73, v102
    v_mul_f32 v102, v26, v103
    v_fmac_f32 v102, v73, v119
    v_mul_f32 v119, v72, v119
    v_fmac_f32 v119, v73, v103
    v_mul_f32 v103, v26, v104
    v_fmac_f32 v103, v73, v120
    v_mul_f32 v120, v72, v120
    v_fmac_f32 v120, v73, v104
    v_mul_f32 v104, v26, v105
    v_fmac_f32 v104, v73, v121
    v_mul_f32 v121, v72, v121
    v_fmac_f32 v121, v73, v105
    v_mul_f32 v105, v26, v106
    v_fmac_f32 v105, v73, v122
    v_mul_f32 v122, v72, v122
    v_fmac_f32 v122, v73, v106
    v_mul_f32 v106, v26, v107
    v_fmac_f32 v106, v73, v123
    v_mul_f32 v123, v72, v123
    v_fmac_f32 v123, v73, v107
    v_mul_f32 v107, v26, v108
    v_fmac_f32 v107, v73, v124
    v_mul_f32 v124, v72, v124
    v_fmac_f32 v124, v73, v108
    v_mul_f32 v108, v26, v109
    v_fmac_f32 v108, v73, v125
    v_mul_f32 v125, v72, v125
    v_fmac_f32 v125, v73, v109
    v_mul_f32 v109, v26, v110
    v_fmac_f32 v109, v73, v126
    v_mul_f32 v126, v72, v126
    v_fmac_f32 v126, v73, v110
    v_mul_f32 v110, v26, v111
    v_fmac_f32 v110, v73, v127
    v_mul_f32 v127, v72, v127
    v_fmac_f32 v127, v73, v111
    s_mul_i32 s30, s44, 24576
    s_add_u32 s30, s30, 24576
    s_sub_u32 s30, s30, s45
    v_add_u32 v20, s30, v20
    v_add_u32 v21, s30, v21
    v_add_u32 v22, s30, v22
    v_add_u32_e64 v23, s30, v23
    v_lshl_add_u32 v8, v9, 1, s72
    global_load_ushort v11, v8, s[86:87]
    s_waitcnt vmcnt(12)
    s_barrier
    buffer_load_dwordx4 v[40:43], v10, s[8:11], s64 offen sc1
    buffer_load_dwordx4 v[44:47], v10, s[8:11], s65 offen sc1
    ds_read_b128 v[160:163], v20 offset:0
    ds_read_b128 v[164:167], v20 offset:4096
    ds_read_b128 v[168:171], v21 offset:0
    ds_read_b128 v[172:175], v21 offset:4096
    ds_read_b128 v[176:179], v22 offset:0
    ds_read_b128 v[180:183], v22 offset:4096
    ds_read_b128 v[184:187], v23 offset:0
    ds_read_b128 v[188:191], v23 offset:4096
    ds_read_b128 v[192:195], v20 offset:8192
    ds_read_b128 v[196:199], v20 offset:12288
    ds_read_b128 v[200:203], v21 offset:8192
    ds_read_b128 v[204:207], v21 offset:12288
    ds_read_b128 v[208:211], v22 offset:8192
    ds_read_b128 v[212:215], v22 offset:12288
    ds_read_b128 v[216:219], v23 offset:8192
    ds_read_b128 v[220:223], v23 offset:12288
    ds_read_b128 v[224:227], v20 offset:16384
    ds_read_b128 v[228:231], v20 offset:20480
    ds_read_b128 v[232:235], v21 offset:16384
    ds_read_b128 v[236:239], v21 offset:20480
    ds_read_b128 v[240:243], v22 offset:16384
    ds_read_b128 v[244:247], v22 offset:20480
    ds_read_b128 v[248:251], v23 offset:16384
    ds_read_b128 v[252:255], v23 offset:20480
    s_lshl_b32 s30, s44, 13
    s_sub_u32 s30, s30, 24576
    v_add_u32 v20, s30, v20
    v_add_u32 v21, s30, v21
    v_add_u32 v22, s30, v22
    v_add_u32 v23, s30, v23
    s_branch L_b_es1
L_b_es:
    buffer_load_dwordx4 v[40:43], v10, s[8:11], s64 offen sc1
    buffer_load_dwordx4 v[44:47], v10, s[8:11], s65 offen sc1
    s_add_u32 s29, s29, 1
    s_cmp_gt_u32 s29, 131072
    s_cbranch_scc1 L_end
L_b_es1:
    s_setprio 2
    s_waitcnt vmcnt(0)
    v_cmp_ne_u32 s[30:31], s28, v42
    v_cmp_ne_u32 s[32:33], s28, v46
    v_cndmask_b32 v40, 0, v40, s[52:53]
    v_cndmask_b32 v41, 0, v41, s[52:53]
    s_and_b64 s[30:31], s[30:31], s[52:53]
    s_and_b64 s[32:33], s[32:33], s[54:55]
    s_or_b64 s[30:31], s[30:31], s[32:33]
    s_cbranch_scc1 L_b_es
    v_cndmask_b32 v44, 0, v44, s[54:55]
    v_cndmask_b32 v45, 0, v45, s[54:55]
    v_mul_f32 v46, v41, v35
    v_mul_f32 v43, v41, v34
    v_fma_f32 v42, v40, v34, -v46
    v_fmac_f32_e64 v43, v40, v35
    v_fma_f32 v42, -v45, v37, v42
    v_fmac_f32 v43, v45, v36
    v_fmac_f32 v42, v44, v36
    v_fmac_f32_e64 v43, v44, v37
    ds_write_b64 v61, v[42:43]
    s_waitcnt lgkmcnt(0)
    s_barrier
    ds_read_b64 v[128:129], v60 offset:0
    ds_read_b64 v[130:131], v60 offset:256
    ds_read_b64 v[132:133], v60 offset:512
    ds_read_b64 v[134:135], v60 offset:768
    ds_read_b64 v[136:137], v60 offset:1024
    ds_read_b64 v[138:139], v60 offset:1280
    ds_read_b64 v[140:141], v60 offset:1536
    ds_read_b64 v[142:143], v60 offset:1792
    s_waitcnt lgkmcnt(5)
    v_add_f32 v128, v128, v130
    v_add_f32 v129, v129, v131
    v_add_f32 v128, v128, v132
    v_add_f32 v129, v129, v133
    s_waitcnt lgkmcnt(3)
    v_add_f32 v128, v128, v134
    v_add_f32 v129, v129, v135
    v_add_f32 v128, v128, v136
    v_add_f32 v129, v129, v137
    s_waitcnt lgkmcnt(1)
    v_add_f32 v128, v128, v138
    v_add_f32 v129, v129, v139
    v_add_f32 v128, v128, v140
    v_add_f32 v129, v129, v141
    s_waitcnt lgkmcnt(0)
    v_add_f32 v128, v128, v142
    v_add_f32 v129, v129, v143
    v_fma_f32 v38, -v31, v129, v38
    v_fmac_f32 v39, v31, v128
    v_fmac_f32 v38, v30, v128
    v_fmac_f32 v39, v30, v129
    v_mul_f32 v74, v26, v38
    v_mul_f32 v75, v72, v39
    v_fmac_f32 v74, v73, v39
    v_fmac_f32 v75, v73, v38
    v_fmac_f32 v63, v25, v75
    v_fmac_f32 v112, v32, v74
    v_fmac_f32 v63, v24, v74
    v_fmac_f32 v112, v24, v75
    v_fmac_f32 v96, v25, v112
    v_fmac_f32 v113, v32, v63
    v_fmac_f32 v96, v24, v63
    v_fmac_f32_e64 v113, v24, v112
    v_cvt_pk_bf16_f32 v64, v63, v96
    v_cvt_pk_bf16_f32 v80, v112, v113
    v_fmac_f32 v97, v25, v113
    v_fmac_f32 v114, v32, v96
    v_fmac_f32 v97, v24, v96
    v_fmac_f32 v114, v24, v113
    v_fmac_f32 v98, v25, v114
    v_fmac_f32 v115, v32, v97
    v_fmac_f32 v98, v24, v97
    v_fmac_f32 v115, v24, v114
    v_cvt_pk_bf16_f32 v65, v97, v98
    v_cvt_pk_bf16_f32 v81, v114, v115
    v_fmac_f32 v99, v25, v115
    v_fmac_f32 v116, v32, v98
    v_fmac_f32 v99, v24, v98
    v_fmac_f32 v116, v24, v115
    v_fmac_f32 v100, v25, v116
    v_fmac_f32 v117, v32, v99
    v_fmac_f32 v100, v24, v99
    v_fmac_f32 v117, v24, v116
    v_cvt_pk_bf16_f32 v66, v99, v100
    v_cvt_pk_bf16_f32 v82, v116, v117
    v_fmac_f32 v101, v25, v117
    v_fmac_f32 v118, v32, v100
    v_fmac_f32 v101, v24, v100
    v_fmac_f32 v118, v24, v117
    v_fmac_f32 v102, v25, v118
    v_fmac_f32 v119, v32, v101
    v_fmac_f32 v102, v24, v101
    v_fmac_f32 v119, v24, v118
    v_cvt_pk_bf16_f32 v67, v101, v102
    v_cvt_pk_bf16_f32 v83, v118, v119
    v_fmac_f32 v103, v25, v119
    v_fmac_f32 v120, v32, v102
    v_fmac_f32 v103, v24, v102
    v_fmac_f32 v120, v24, v119
    v_mfma_f32_32x32x16_bf16 v[128:143], v[64:67], v[48:51], 0
    v_fmac_f32 v104, v25, v120
    v_fmac_f32 v121, v32, v103
    v_fmac_f32 v104, v24, v103
    v_fmac_f32 v121, v24, v120
    v_mfma_f32_32x32x16_bf16 v[144:159], v[80:83], v[48:51], 0
    v_cvt_pk_bf16_f32 v68, v103, v104
    v_cvt_pk_bf16_f32 v84, v120, v121
    v_fmac_f32 v105, v25, v121
    v_fmac_f32 v122, v32, v104
    v_fmac_f32 v105, v24, v104
    v_fmac_f32 v122, v24, v121
    v_fmac_f32 v106, v25, v122
    v_fmac_f32 v123, v32, v105
    v_fmac_f32 v106, v24, v105
    v_fmac_f32 v123, v24, v122
    v_cvt_pk_bf16_f32 v69, v105, v106
    v_cvt_pk_bf16_f32 v85, v122, v123
    v_fmac_f32 v107, v25, v123
    v_fmac_f32 v124, v32, v106
    v_fmac_f32 v107, v24, v106
    v_fmac_f32 v124, v24, v123
    v_fmac_f32 v108, v25, v124
    v_fmac_f32 v125, v32, v107
    v_fmac_f32 v108, v24, v107
    v_fmac_f32 v125, v24, v124
    v_cvt_pk_bf16_f32 v70, v107, v108
    v_cvt_pk_bf16_f32 v86, v124, v125
    v_fmac_f32 v109, v25, v125
    v_fmac_f32 v126, v32, v108
    v_fmac_f32 v109, v24, v108
    v_fmac_f32 v126, v24, v125
    v_fmac_f32 v110, v25, v126
    v_fmac_f32 v127, v32, v109
    v_fmac_f32 v110, v24, v109
    v_fmac_f32 v127, v24, v126
    v_cvt_pk_bf16_f32 v71, v109, v110
    v_cvt_pk_bf16_f32 v87, v126, v127
    s_nop 0
    v_mfma_f32_32x32x16_bf16 v[128:143], v[68:71], v[52:55], v[128:143]
    v_mfma_f32_32x32x16_bf16 v[144:159], v[84:87], v[52:55], v[144:159]
    v_mul_u32_u24 v10, 14336, v14
    v_lshl_add_u32 v10, v9, 2, v10
    s_nop 2
    s_nop 5
    s_nop 0
    v_perm_b32 v128, v129, v128, s77
    v_perm_b32 v129, v131, v130, s77
    v_perm_b32 v130, v133, v132, s77
    v_perm_b32 v131, v135, v134, s77
    buffer_store_dwordx4 v[128:131], v0, s[8:11], s67 offen offset:0 sc1
    v_perm_b32 v132, v137, v136, s77
    v_perm_b32 v133, v139, v138, s77
    v_perm_b32 v134, v141, v140, s77
    v_perm_b32 v135, v143, v142, s77
    buffer_store_dwordx4 v[132:135], v0, s[8:11], s67 offen offset:1024 sc1
    v_perm_b32 v144, v145, v144, s77
    v_perm_b32 v145, v147, v146, s77
    v_perm_b32 v146, v149, v148, s77
    v_perm_b32 v147, v151, v150, s77
    buffer_store_dwordx4 v[144:147], v0, s[8:11], s68 offen offset:0 sc1
    v_perm_b32 v148, v153, v152, s77
    v_perm_b32 v149, v155, v154, s77
    v_perm_b32 v150, v157, v156, s77
    v_perm_b32 v151, v159, v158, s77
    buffer_store_dwordx4 v[148:151], v0, s[8:11], s68 offen offset:1024 sc1
    s_waitcnt vmcnt(0)
    s_barrier
    s_cmp_lg_u32 s3, 0
    s_cbranch_scc1 L_pf2993
    v_mov_b32 v45, s28
    s_mov_b64 exec, 1
    buffer_store_dword v45, v2, s[8:11], s73 offen sc1
    s_mov_b64 exec, -1
L_pf2993:
    s_add_u32 m0, s46, 65536
    s_nop 0
    buffer_load_dwordx4 v6, s[20:23], s70 offen lds
    s_add_u32 m0, s46, 66560
    s_nop 0
    buffer_load_dwordx4 v7, s[20:23], s70 offen lds
    s_add_u32 s49, s35, 768
    s_add_u32 m0, s46, 24576
    s_nop 0
    buffer_load_dwordx4 v6, s[56:59], s49 offen lds
    s_add_u32 m0, s46, 25600
    s_nop 0
    buffer_load_dwordx4 v7, s[56:59], s49 offen lds
    s_add_u32 s49, s35, 384
    s_add_u32 m0, s46, 32768
    s_nop 0
    buffer_load_dwordx4 v6, s[60:63], s49 offen lds
    s_add_u32 m0, s46, 33792
    s_nop 0
    buffer_load_dwordx4 v7, s[60:63], s49 offen lds
    s_add_u32 s49, s35, 512
    s_add_u32 m0, s46, 40960
    s_nop 0
    buffer_load_dwordx4 v6, s[60:63], s49 offen lds
    s_add_u32 m0, s46, 41984
    s_nop 0
    buffer_load_dwordx4 v7, s[60:63], s49 offen lds
    s_add_u32 s49, s35, 640
    s_add_u32 m0, s46, 49152
    s_nop 0
    buffer_load_dwordx4 v6, s[60:63], s49 offen lds
    s_add_u32 m0, s46, 50176
    s_nop 0
    buffer_load_dwordx4 v7, s[60:63], s49 offen lds
    s_add_u32 s49, s35, 768
    s_add_u32 m0, s46, 57344
    s_nop 0
    buffer_load_dwordx4 v6, s[60:63], s49 offen lds
    s_add_u32 m0, s46, 58368
    s_nop 0
    buffer_load_dwordx4 v7, s[60:63], s49 offen lds
    v_lshlrev_b32 v28, 16, v11
    v_lshlrev_b32 v29, 3, v14
    v_sub_u32 v29, v9, v29
    v_cmp_eq_u32 s[88:89], 0, v29
    v_cmp_eq_u32 s[50:51], 2, v29
    v_cmp_eq_u32 s[78:79], 1, v29
    v_cndmask_b32 v32, 0, v11, s[88:89]
    v_cmp_eq_u32 s[88:89], 3, v29
    v_cndmask_b32 v33, 0, v11, s[50:51]
    v_cndmask_b32 v32, v32, v28, s[78:79]
    v_cndmask_b32 v33, v33, v28, s[88:89]
    v_cmp_eq_u32 s[88:89], 4, v29
    v_cmp_eq_u32 s[50:51], 6, v29
    v_cmp_eq_u32 s[78:79], 5, v29
    v_cndmask_b32 v34, 0, v11, s[88:89]
    v_cmp_eq_u32 s[88:89], 7, v29
    v_cndmask_b32 v35, 0, v11, s[50:51]
    v_cndmask_b32 v34, v34, v28, s[78:79]
    v_cndmask_b32 v35, v35, v28, s[88:89]
    v_cmp_eq_u32 s[88:89], 16, v29
    v_cmp_eq_u32 s[50:51], 18, v29
    v_cmp_eq_u32 s[78:79], 17, v29
    v_cndmask_b32 v36, 0, v11, s[88:89]
    v_cmp_eq_u32 s[88:89], 19, v29
    v_cndmask_b32 v37, 0, v11, s[50:51]
    v_cndmask_b32 v36, v36, v28, s[78:79]
    v_cndmask_b32 v37, v37, v28, s[88:89]
    v_cmp_eq_u32 s[88:89], 20, v29
    v_cmp_eq_u32 s[50:51], 22, v29
    v_cmp_eq_u32 s[78:79], 21, v29
    v_cndmask_b32 v38, 0, v11, s[88:89]
    v_cmp_eq_u32 s[88:89], 23, v29
    v_cndmask_b32 v39, 0, v11, s[50:51]
    v_cndmask_b32 v38, v38, v28, s[78:79]
    v_cndmask_b32 v39, v39, v28, s[88:89]
    s_cmp_eq_u32 s44, 0
    s_cselect_b64 vcc, -1, 0
    s_lshl_b32 s30, s43, 12
    s_add_u32 s30, s30, 65536
    s_lshl_b32 s31, s44, 15
    s_sub_u32 s30, s30, s31
    v_cndmask_b32 v12, v22, v20, vcc
    v_cndmask_b32 v13, v23, v21, vcc
    v_add_u32 v12, s30, v12
    v_add_u32 v13, s30, v13
    s_cmp_lg_u32 s3, 0
    s_cbranch_scc1 L_b_nopoll
    s_mov_b32 exec_hi, 0
    s_mov_b32 exec_lo, 0x3fff
L_b4_poll:
    buffer_load_dword v45, v62, s[8:11], s74 offen sc1
    s_add_u32 s29, s29, 1
    s_cmp_gt_u32 s29, 131072
    s_cbranch_scc1 L_end
    s_waitcnt vmcnt(0)
    v_cmp_ne_u32 vcc, s28, v45
    s_cbranch_vccnz L_b4_poll
    s_mov_b64 exec, -1
L_b_nopoll:
    s_barrier
    s_add_u32 s69, s76, 0
    buffer_load_dwordx4 v[64:67], v0, s[8:11], s69 offen offset:0 sc1
    buffer_load_dwordx4 v[68:71], v0, s[8:11], s69 offen offset:1024 sc1
    buffer_load_dwordx4 v[72:75], v0, s[8:11], s69 offen offset:2048 sc1
    buffer_load_dwordx4 v[76:79], v0, s[8:11], s69 offen offset:3072 sc1
    s_add_u32 s69, s76, 4096
    buffer_load_dwordx4 v[80:83], v0, s[8:11], s69 offen offset:0 sc1
    buffer_load_dwordx4 v[84:87], v0, s[8:11], s69 offen offset:1024 sc1
    buffer_load_dwordx4 v[88:91], v0, s[8:11], s69 offen offset:2048 sc1
    buffer_load_dwordx4 v[92:95], v0, s[8:11], s69 offen offset:3072 sc1
    s_add_u32 s69, s76, 8192
    buffer_load_dwordx4 v[96:99], v0, s[8:11], s69 offen offset:0 sc1
    s_setprio 0
    s_waitcnt vmcnt(8)
L_b_back0:
    v_mfma_f32_32x32x16_bf16 v[128:143], v[64:67], v[160:163], 0
    s_waitcnt vmcnt(7)
L_b_back1:
    v_mfma_f32_32x32x16_bf16 v[144:159], v[64:67], v[164:167], 0
    buffer_load_dwordx4 v[100:103], v0, s[8:11], s69 offen offset:1024 sc1
    v_mfma_f32_32x32x16_bf16 v[128:143], v[68:71], v[168:171], v[128:143]
    s_waitcnt vmcnt(7)
L_b_back2:
    v_mfma_f32_32x32x16_bf16 v[144:159], v[68:71], v[172:175], v[144:159]
    buffer_load_dwordx4 v[104:107], v0, s[8:11], s69 offen offset:2048 sc1
    v_mfma_f32_32x32x16_bf16 v[128:143], v[72:75], v[176:179], v[128:143]
    s_waitcnt vmcnt(7)
L_b_back3:
    v_mfma_f32_32x32x16_bf16 v[144:159], v[72:75], v[180:183], v[144:159]
    buffer_load_dwordx4 v[108:111], v0, s[8:11], s69 offen offset:3072 sc1
    v_mfma_f32_32x32x16_bf16 v[128:143], v[76:79], v[184:187], v[128:143]
    s_waitcnt vmcnt(7)
L_b_back4:
    v_mfma_f32_32x32x16_bf16 v[144:159], v[76:79], v[188:191], v[144:159]
    s_add_u32 s69, s76, 12288
    buffer_load_dwordx4 v[112:115], v0, s[8:11], s69 offen offset:0 sc1
    v_mfma_f32_32x32x16_bf16 v[128:143], v[80:83], v[192:195], v[128:143]
    s_waitcnt vmcnt(7)
L_b_back5:
    v_mfma_f32_32x32x16_bf16 v[144:159], v[80:83], v[196:199], v[144:159]
    buffer_load_dwordx4 v[116:119], v0, s[8:11], s69 offen offset:1024 sc1
    v_mfma_f32_32x32x16_bf16 v[128:143], v[84:87], v[200:203], v[128:143]
    s_waitcnt vmcnt(7)
L_b_back6:
    v_mfma_f32_32x32x16_bf16 v[144:159], v[84:87], v[204:207], v[144:159]
    buffer_load_dwordx4 v[120:123], v0, s[8:11], s69 offen offset:2048 sc1
    v_mfma_f32_32x32x16_bf16 v[128:143], v[88:91], v[208:211], v[128:143]
    s_waitcnt vmcnt(7)
L_b_back7:
    v_mfma_f32_32x32x16_bf16 v[144:159], v[88:91], v[212:215], v[144:159]
    buffer_load_dwordx4 v[124:127], v0, s[8:11], s69 offen offset:3072 sc1
    v_mfma_f32_32x32x16_bf16 v[128:143], v[92:95], v[216:219], v[128:143]
    s_waitcnt vmcnt(7)
L_b_back8:
    v_mfma_f32_32x32x16_bf16 v[144:159], v[92:95], v[220:223], v[144:159]
    s_add_u32 s69, s76, 16384
    buffer_load_dwordx4 v[64:67], v0, s[8:11], s69 offen offset:0 sc1
    s_barrier
    ds_read_b128 v[16:19], v12
    ds_read_b128 v[24:27], v13
    ds_read_b128 v[160:163], v20 offset:0
    ds_read_b128 v[164:167], v20 offset:4096
    v_mfma_f32_32x32x16_bf16 v[128:143], v[96:99], v[224:227], v[128:143]
    s_waitcnt vmcnt(7)
L_b_back9:
    v_mfma_f32_32x32x16_bf16 v[144:159], v[96:99], v[228:231], v[144:159]
    buffer_load_dwordx4 v[68:71], v0, s[8:11], s69 offen offset:1024 sc1
    ds_read_b128 v[168:171], v21 offset:0
    ds_read_b128 v[172:175], v21 offset:4096
    v_mfma_f32_32x32x16_bf16 v[128:143], v[100:103], v[232:235], v[128:143]
    s_waitcnt vmcnt(7)
L_b_back10:
    v_mfma_f32_32x32x16_bf16 v[144:159], v[100:103], v[236:239], v[144:159]
    buffer_load_dwordx4 v[72:75], v0, s[8:11], s69 offen offset:2048 sc1
    ds_read_b128 v[176:179], v22 offset:0
    ds_read_b128 v[180:183], v22 offset:4096
    v_mfma_f32_32x32x16_bf16 v[128:143], v[104:107], v[240:243], v[128:143]
    s_waitcnt vmcnt(7)
L_b_back11:
    v_mfma_f32_32x32x16_bf16 v[144:159], v[104:107], v[244:247], v[144:159]
    buffer_load_dwordx4 v[76:79], v0, s[8:11], s69 offen offset:3072 sc1
    ds_read_b128 v[184:187], v23 offset:0
    ds_read_b128 v[188:191], v23 offset:4096
    v_mfma_f32_32x32x16_bf16 v[128:143], v[108:111], v[248:251], v[128:143]
    s_waitcnt vmcnt(7)
L_b_back12:
    v_mfma_f32_32x32x16_bf16 v[144:159], v[108:111], v[252:255], v[144:159]
    s_add_u32 s69, s76, 20480
    buffer_load_dwordx4 v[80:83], v0, s[8:11], s69 offen offset:0 sc1
    ds_read_b128 v[192:195], v20 offset:8192
    ds_read_b128 v[196:199], v20 offset:12288
    s_waitcnt lgkmcnt(8)
    s_barrier
    v_mfma_f32_32x32x16_bf16 v[48:63], v[16:19], v[32:35], 0
    v_mfma_f32_32x32x16_bf16 v[48:63], v[24:27], v[36:39], v[48:63]
    v_mfma_f32_32x32x16_bf16 v[128:143], v[112:115], v[160:163], v[128:143]
    s_waitcnt vmcnt(7)
L_b_back13:
    v_mfma_f32_32x32x16_bf16 v[144:159], v[112:115], v[164:167], v[144:159]
    buffer_load_dwordx4 v[84:87], v0, s[8:11], s69 offen offset:1024 sc1
    ds_read_b128 v[200:203], v21 offset:8192
    ds_read_b128 v[204:207], v21 offset:12288
    s_waitcnt lgkmcnt(8)
    v_mfma_f32_32x32x16_bf16 v[128:143], v[116:119], v[168:171], v[128:143]
    s_waitcnt vmcnt(7)
L_b_back14:
    v_mfma_f32_32x32x16_bf16 v[144:159], v[116:119], v[172:175], v[144:159]
    buffer_load_dwordx4 v[88:91], v0, s[8:11], s69 offen offset:2048 sc1
    ds_read_b128 v[208:211], v22 offset:8192
    ds_read_b128 v[212:215], v22 offset:12288
    s_waitcnt lgkmcnt(8)
    v_mfma_f32_32x32x16_bf16 v[128:143], v[120:123], v[176:179], v[128:143]
    s_waitcnt vmcnt(7)
L_b_back15:
    v_mfma_f32_32x32x16_bf16 v[144:159], v[120:123], v[180:183], v[144:159]
    buffer_load_dwordx4 v[92:95], v0, s[8:11], s69 offen offset:3072 sc1
    ds_read_b128 v[216:219], v23 offset:8192
    ds_read_b128 v[220:223], v23 offset:12288
    s_waitcnt lgkmcnt(8)
    v_mfma_f32_32x32x16_bf16 v[128:143], v[124:127], v[184:187], v[128:143]
    s_waitcnt vmcnt(7)
L_b_back16:
    v_mfma_f32_32x32x16_bf16 v[144:159], v[124:127], v[188:191], v[144:159]
    s_add_u32 s69, s76, 24576
    buffer_load_dwordx4 v[96:99], v0, s[8:11], s69 offen offset:0 sc1
    ds_read_b128 v[224:227], v20 offset:16384
    ds_read_b128 v[228:231], v20 offset:20480
    s_waitcnt lgkmcnt(8)
    v_mfma_f32_32x32x16_bf16 v[128:143], v[64:67], v[192:195], v[128:143]
    s_waitcnt vmcnt(7)
L_b_back17:
    v_mfma_f32_32x32x16_bf16 v[144:159], v[64:67], v[196:199], v[144:159]
    buffer_load_dwordx4 v[100:103], v0, s[8:11], s69 offen offset:1024 sc1
    ds_read_b128 v[232:235], v21 offset:16384
    ds_read_b128 v[236:239], v21 offset:20480
    s_waitcnt lgkmcnt(8)
    v_mfma_f32_32x32x16_bf16 v[128:143], v[68:71], v[200:203], v[128:143]
    s_waitcnt vmcnt(7)
L_b_back18:
    v_mfma_f32_32x32x16_bf16 v[144:159], v[68:71], v[204:207], v[144:159]
    buffer_load_dwordx4 v[104:107], v0, s[8:11], s69 offen offset:2048 sc1
    ds_read_b128 v[240:243], v22 offset:16384
    ds_read_b128 v[244:247], v22 offset:20480
    s_waitcnt lgkmcnt(8)
    v_mfma_f32_32x32x16_bf16 v[128:143], v[72:75], v[208:211], v[128:143]
    s_waitcnt vmcnt(7)
L_b_back19:
    v_mfma_f32_32x32x16_bf16 v[144:159], v[72:75], v[212:215], v[144:159]
    buffer_load_dwordx4 v[108:111], v0, s[8:11], s69 offen offset:3072 sc1
    ds_read_b128 v[248:251], v23 offset:16384
    ds_read_b128 v[252:255], v23 offset:20480
    s_waitcnt lgkmcnt(8)
    v_mfma_f32_32x32x16_bf16 v[128:143], v[76:79], v[216:219], v[128:143]
    s_waitcnt vmcnt(7)
L_b_back20:
    v_mfma_f32_32x32x16_bf16 v[144:159], v[76:79], v[220:223], v[144:159]
    ds_read_b128 v[160:163], v20 offset:24576
    ds_read_b128 v[164:167], v20 offset:28672
    s_waitcnt lgkmcnt(8)
    v_mfma_f32_32x32x16_bf16 v[128:143], v[80:83], v[224:227], v[128:143]
    s_waitcnt vmcnt(6)
L_b_back21:
    v_mfma_f32_32x32x16_bf16 v[144:159], v[80:83], v[228:231], v[144:159]
    ds_read_b128 v[168:171], v21 offset:24576
    ds_read_b128 v[172:175], v21 offset:28672
    s_waitcnt lgkmcnt(8)
    v_mfma_f32_32x32x16_bf16 v[128:143], v[84:87], v[232:235], v[128:143]
    s_waitcnt vmcnt(5)
L_b_back22:
    v_mfma_f32_32x32x16_bf16 v[144:159], v[84:87], v[236:239], v[144:159]
    ds_read_b128 v[176:179], v22 offset:24576
    ds_read_b128 v[180:183], v22 offset:28672
    s_waitcnt lgkmcnt(8)
    v_mfma_f32_32x32x16_bf16 v[128:143], v[88:91], v[240:243], v[128:143]
    s_waitcnt vmcnt(4)
L_b_back23:
    v_mfma_f32_32x32x16_bf16 v[144:159], v[88:91], v[244:247], v[144:159]
    ds_read_b128 v[184:187], v23 offset:24576
    ds_read_b128 v[188:191], v23 offset:28672
    s_waitcnt lgkmcnt(8)
    v_mfma_f32_32x32x16_bf16 v[128:143], v[92:95], v[248:251], v[128:143]
    s_waitcnt vmcnt(3)
L_b_back24:
    v_mfma_f32_32x32x16_bf16 v[144:159], v[92:95], v[252:255], v[144:159]
    s_waitcnt lgkmcnt(6)
    v_mfma_f32_32x32x16_bf16 v[128:143], v[96:99], v[160:163], v[128:143]
    s_waitcnt vmcnt(2)
L_b_back25:
    v_mfma_f32_32x32x16_bf16 v[144:159], v[96:99], v[164:167], v[144:159]
    s_waitcnt lgkmcnt(4)
    v_mfma_f32_32x32x16_bf16 v[128:143], v[100:103], v[168:171], v[128:143]
    s_waitcnt vmcnt(1)
L_b_back26:
    v_mfma_f32_32x32x16_bf16 v[144:159], v[100:103], v[172:175], v[144:159]
    s_waitcnt lgkmcnt(2)
    v_mfma_f32_32x32x16_bf16 v[128:143], v[104:107], v[176:179], v[128:143]
    s_waitcnt vmcnt(0)
L_b_back27:
    v_mfma_f32_32x32x16_bf16 v[144:159], v[104:107], v[180:183], v[144:159]
    s_waitcnt lgkmcnt(0)
    v_mfma_f32_32x32x16_bf16 v[128:143], v[108:111], v[184:187], v[128:143]
    v_mfma_f32_32x32x16_bf16 v[144:159], v[108:111], v[188:191], v[144:159]
    s_setprio 2
    s_lshl_b32 s30, s3, 12
    s_add_u32 s30, s30, 65536
    v_add_u32 v4, s30, v0
    v_xor_b32 v5, 0x2000, v4
    s_cmp_lg_u32 s44, 0
    s_nop 7
    s_cbranch_scc1 L_b_red1
    ds_write_b128 v4, v[144:147] offset:0
    ds_write_b128 v4, v[148:151] offset:1024
    ds_write_b128 v4, v[152:155] offset:2048
    ds_write_b128 v4, v[156:159] offset:3072
    v_add_f32 v48, v48, v128
    v_add_f32 v49, v49, v129
    v_add_f32 v50, v50, v130
    v_add_f32 v51, v51, v131
    v_add_f32 v52, v52, v132
    v_add_f32 v53, v53, v133
    v_add_f32 v54, v54, v134
    v_add_f32 v55, v55, v135
    v_add_f32 v56, v56, v136
    v_add_f32 v57, v57, v137
    v_add_f32 v58, v58, v138
    v_add_f32 v59, v59, v139
    v_add_f32 v60, v60, v140
    v_add_f32 v61, v61, v141
    v_add_f32 v62, v62, v142
    v_add_f32_e64 v63, v63, v143
    s_waitcnt lgkmcnt(0)
    s_barrier
    ds_read_b128 v[64:67], v5 offset:0
    ds_read_b128 v[68:71], v5 offset:1024
    ds_read_b128 v[72:75], v5 offset:2048
    ds_read_b128 v[76:79], v5 offset:3072
    s_add_u32 s31, s71, 7168
    s_waitcnt lgkmcnt(3)
    v_add_f32 v64, v64, v48
    v_add_f32 v65, v65, v49
    v_add_f32 v66, v66, v50
    v_add_f32_e64 v67, v67, v51
    buffer_store_dword v64, v10, s[12:15], s71 offen offset:0 sc1
    buffer_store_dword v65, v10, s[12:15], s71 offen offset:3584 sc1
    buffer_store_dword v66, v10, s[12:15], s31 offen offset:0 sc1
    buffer_store_dword v67, v10, s[12:15], s31 offen offset:3584 sc1
    s_add_u32 s71, s71, 28672
    s_add_u32 s31, s31, 28672
    s_waitcnt lgkmcnt(2)
    v_add_f32 v68, v68, v52
    v_add_f32 v69, v69, v53
    v_add_f32 v70, v70, v54
    v_add_f32_e64 v71, v71, v55
    buffer_store_dword v68, v10, s[12:15], s71 offen offset:0 sc1
    buffer_store_dword v69, v10, s[12:15], s71 offen offset:3584 sc1
    buffer_store_dword v70, v10, s[12:15], s31 offen offset:0 sc1
    buffer_store_dword v71, v10, s[12:15], s31 offen offset:3584 sc1
    s_add_u32 s71, s71, 28672
    s_add_u32 s31, s31, 28672
    s_waitcnt lgkmcnt(1)
    v_add_f32 v72, v72, v56
    v_add_f32 v73, v73, v57
    v_add_f32 v74, v74, v58
    v_add_f32_e64 v75, v75, v59
    buffer_store_dword v72, v10, s[12:15], s71 offen offset:0 sc1
    buffer_store_dword v73, v10, s[12:15], s71 offen offset:3584 sc1
    buffer_store_dword v74, v10, s[12:15], s31 offen offset:0 sc1
    buffer_store_dword v75, v10, s[12:15], s31 offen offset:3584 sc1
    s_add_u32 s71, s71, 28672
    s_add_u32 s31, s31, 28672
    s_waitcnt lgkmcnt(0)
    v_add_f32 v76, v76, v60
    v_add_f32 v77, v77, v61
    v_add_f32 v78, v78, v62
    v_add_f32_e64 v79, v79, v63
    buffer_store_dword v76, v10, s[12:15], s71 offen offset:0 sc1
    buffer_store_dword v77, v10, s[12:15], s71 offen offset:3584 sc1
    buffer_store_dword v78, v10, s[12:15], s31 offen offset:0 sc1
    buffer_store_dword v79, v10, s[12:15], s31 offen offset:3584 sc1
    s_endpgm
L_b_red1:
    ds_write_b128 v4, v[128:131] offset:0
    ds_write_b128 v4, v[132:135] offset:1024
    ds_write_b128 v4, v[136:139] offset:2048
    ds_write_b128 v4, v[140:143] offset:3072
    v_add_f32 v48, v48, v144
    v_add_f32 v49, v49, v145
    v_add_f32 v50, v50, v146
    v_add_f32 v51, v51, v147
    v_add_f32 v52, v52, v148
    v_add_f32 v53, v53, v149
    v_add_f32 v54, v54, v150
    v_add_f32 v55, v55, v151
    v_add_f32 v56, v56, v152
    v_add_f32 v57, v57, v153
    v_add_f32 v58, v58, v154
    v_add_f32 v59, v59, v155
    v_add_f32 v60, v60, v156
    v_add_f32 v61, v61, v157
    v_add_f32 v62, v62, v158
    v_add_f32_e64 v63, v63, v159
    s_waitcnt lgkmcnt(0)
    s_barrier
    ds_read_b128 v[64:67], v5 offset:0
    ds_read_b128 v[68:71], v5 offset:1024
    ds_read_b128 v[72:75], v5 offset:2048
    ds_read_b128 v[76:79], v5 offset:3072
    s_add_u32 s31, s71, 7168
    s_waitcnt lgkmcnt(3)
    v_add_f32 v64, v64, v48
    v_add_f32 v65, v65, v49
    v_add_f32 v66, v66, v50
    v_add_f32_e64 v67, v67, v51
    buffer_store_dword v64, v10, s[12:15], s71 offen offset:0 sc1
    buffer_store_dword v65, v10, s[12:15], s71 offen offset:3584 sc1
    buffer_store_dword v66, v10, s[12:15], s31 offen offset:0 sc1
    buffer_store_dword v67, v10, s[12:15], s31 offen offset:3584 sc1
    s_add_u32 s71, s71, 28672
    s_add_u32 s31, s31, 28672
    s_waitcnt lgkmcnt(2)
    v_add_f32 v68, v68, v52
    v_add_f32 v69, v69, v53
    v_add_f32 v70, v70, v54
    v_add_f32_e64 v71, v71, v55
    buffer_store_dword v68, v10, s[12:15], s71 offen offset:0 sc1
    buffer_store_dword v69, v10, s[12:15], s71 offen offset:3584 sc1
    buffer_store_dword v70, v10, s[12:15], s31 offen offset:0 sc1
    buffer_store_dword v71, v10, s[12:15], s31 offen offset:3584 sc1
    s_add_u32 s71, s71, 28672
    s_add_u32 s31, s31, 28672
    s_waitcnt lgkmcnt(1)
    v_add_f32 v72, v72, v56
    v_add_f32 v73, v73, v57
    v_add_f32 v74, v74, v58
    v_add_f32_e64 v75, v75, v59
    buffer_store_dword v72, v10, s[12:15], s71 offen offset:0 sc1
    buffer_store_dword v73, v10, s[12:15], s71 offen offset:3584 sc1
    buffer_store_dword v74, v10, s[12:15], s31 offen offset:0 sc1
    buffer_store_dword v75, v10, s[12:15], s31 offen offset:3584 sc1
    s_add_u32 s71, s71, 28672
    s_add_u32 s31, s31, 28672
    s_waitcnt lgkmcnt(0)
    v_add_f32 v76, v76, v60
    v_add_f32 v77, v77, v61
    v_add_f32 v78, v78, v62
    v_add_f32_e64 v79, v79, v63
    buffer_store_dword v76, v10, s[12:15], s71 offen offset:0 sc1
    buffer_store_dword v77, v10, s[12:15], s71 offen offset:3584 sc1
    buffer_store_dword v78, v10, s[12:15], s31 offen offset:0 sc1
    buffer_store_dword v79, v10, s[12:15], s31 offen offset:3584 sc1
    s_endpgm
L_end:
    s_endpgm
L_codeend:
.section .rodata,"a"
.p2align 6
.amdhsa_kernel concat_heads__ssm_conv_s4d__ssm_conv_s5__prompt_kernel
  .amdhsa_next_free_vgpr 256
  .amdhsa_next_free_sgpr 102
  .amdhsa_accum_offset 256
  .amdhsa_group_segment_fixed_size 0
  .amdhsa_kernarg_size 152
  .amdhsa_user_sgpr_count 2
  .amdhsa_user_sgpr_kernarg_segment_ptr 1
  .amdhsa_system_sgpr_workgroup_id_x 1
.end_amdhsa_kernel
```
